```python
import torch

def _softmax(x, axis=-1):
    return torch.softmax(x, dim=axis)
def _gelu(x):
    return torch.nn.functional.gelu(x, approximate="tanh")
def _silu(x):
    return torch.nn.functional.silu(x)
def _sigmoid(x):
    return torch.sigmoid(x)
def _layernorm(x, axis=-1, eps=1e-5):
    m = x.mean(dim=axis, keepdim=True)
    v = x.var(dim=axis, keepdim=True, unbiased=False)
    return (x - m) / torch.sqrt(v + eps)
def _scatter_add(tgt, idx, src, axis=0):
    return tgt.clone().index_add_(axis, idx, src)
def _segment_sum(src, seg, n):
    out = torch.zeros((n,) + src.shape[1:], dtype=src.dtype)
    return out.index_add_(0, seg, src)
def _pad(x, pw):
    flat = tuple(v for pair in reversed(pw) for v in pair)
    return torch.nn.functional.pad(x, flat)

kernel_name = 'concat_heads__ssm_conv_s4d__spectral_gfnet__prompt'

def setup_inputs():

    _w = (lambda a: (lambda t: t.to(torch.bfloat16) if t.is_floating_point() else t)(torch.as_tensor(a)))
    def _A_setup():
        Bsz, L, D, N = 1, 2048, 448, 256
        return {
            "u": _w((lambda *s: torch.randn(*s, dtype=torch.bfloat16) * 0.05)(Bsz, L, D)),
            "log_A_real": _w((lambda *s: torch.randn(*s, dtype=torch.bfloat16) * 6.4)(D, N) * 0.5),
            "A_imag": _w((lambda *s: torch.randn(*s, dtype=torch.bfloat16) * 0.05)(D, N) * 3.14),
            "C_real": _w((lambda *s: torch.randn(*s, dtype=torch.bfloat16) * 0.05)(D, N) / N ** 0.5),
            "C_imag": _w((lambda *s: torch.randn(*s, dtype=torch.bfloat16) * 0.05)(D, N) / N ** 0.5),
            "log_dt": _w((lambda *s: torch.randn(*s, dtype=torch.bfloat16) * 0.05)(D) * 0.5 - 4.0),
            "D_skip": _w((lambda *s: torch.randn(*s, dtype=torch.bfloat16) * 0.05)(D)),
        }
    _A_in = _A_setup()

    def _B_setup():
        B, S, D = 1, 2048, 448
        Df = D // 2 + 1
        return {
            "x": _w((lambda *s: torch.randn(*s, dtype=torch.bfloat16) * 0.05)(B, S, D)),
            "w_r": _w((lambda *s: torch.randn(*s, dtype=torch.bfloat16) * 0.8)(S, Df) * 0.02),
            "w_i": _w((lambda *s: torch.randn(*s, dtype=torch.bfloat16) * 0.8)(S, Df) * 0.02),
        }
    _B_in = _B_setup()

    return {
        "A_u": _A_in["u"],
        "A_log_A_real": _A_in["log_A_real"],
        "A_A_imag": _A_in["A_imag"],
        "A_C_real": _A_in["C_real"],
        "A_C_imag": _A_in["C_imag"],
        "A_log_dt": _A_in["log_dt"],
        "A_D_skip": _A_in["D_skip"],
        "B_x": _B_in["x"],
        "B_w_r": _B_in["w_r"],
        "B_w_i": _B_in["w_i"],
    }

def reference(A_u, A_log_A_real, A_A_imag, A_C_real, A_C_imag, A_log_dt, A_D_skip, B_x, B_w_r, B_w_i):
    def _A_ref(u, log_A_real, A_imag, C_real, C_imag, log_dt, D_skip):
        L = u.shape[1]
        dt = torch.exp(log_dt)
        A = -torch.exp(log_A_real) + 1j * A_imag
        C = (C_real + 1j * C_imag) * dt[:, None]
        pos = (lambda x, dt: x.to(dt))(torch.arange(L), log_dt.dtype)
        P = torch.exp((A * dt[:, None])[:, :, None] * pos[None, None, :])
        K = 2.0 * torch.einsum("dn,dnl->dl", C, P).real
        L2 = 2 * L
        u_t = (lambda x, *d: x.permute(*d))(u, 0, 2, 1)
        Kf = (lambda x, *a, **k: torch.fft.rfft(x.float(), *a, **k))(K, L2)
        Uf = (lambda x, *a, **k: torch.fft.rfft(x.float(), *a, **k))(u_t, L2)
        y = (lambda x, *a, **k: torch.fft.irfft(x, *a, **k).to(torch.bfloat16))(Uf * Kf[None, :, :], L2)[:, :, :L]
        y = (lambda x, *d: x.permute(*d))(y, 0, 2, 1)
        return y + u * D_skip[None, None, :]

    def _B_ref(x, w_r, w_i):
        B, S, D = x.shape
        X = (lambda x, axes=(-2,-1): torch.fft.rfft2(x.float(), dim=axes))(x, axes=(-2, -1))
        W = w_r + 1j * w_i
        X = X * W
        y = (lambda x, s, axes=(-2,-1): torch.fft.irfft2(x, s=s, dim=axes).to(torch.bfloat16))(X, (S, D), axes=(-2, -1))
        return y

    a = _A_ref(A_u, A_log_A_real, A_A_imag, A_C_real, A_C_imag, A_log_dt, A_D_skip)
    b = _B_ref(B_x, B_w_r, B_w_i)
    return torch.concatenate([a, b], axis=-1)
```

```asm
; @launch grid=(496,1,1) block=(512,1,1) lds=78336
.amdgcn_target "amdgcn-amd-amdhsa--gfx950"
.text
.globl concat_heads__ssm_conv_s4d__spectral_gfnet__prompt_kernel
.p2align 8
.type concat_heads__ssm_conv_s4d__spectral_gfnet__prompt_kernel,@function
concat_heads__ssm_conv_s4d__spectral_gfnet__prompt_kernel:
    s_load_dwordx16 s[4:19], s[0:1], 0
    s_load_dwordx8 s[20:27], s[0:1], 64
    s_load_dwordx2 s[32:33], s[0:1], 96
    s_getpc_b64 s[36:37]
L_pc:
    v_cmp_gt_u32 vcc, 10, v0
    s_bfe_u32 s66, s2, 0x50003
    s_mul_i32 s66, s66, 1280
    s_and_saveexec_b64 s[64:65], vcc
    s_cbranch_execz L_nopf
    v_lshl_add_u32 v124, v0, 7, s66
    v_min_u32 v124, L_tbl_end-L_pc-4, v124
    global_load_dword v124, v124, s[36:37]
L_nopf:
    s_mov_b64 exec, -1
    s_cmp_ge_u32 s2, 496
    s_cbranch_scc1 L_end
    s_add_u32 s64, s2, 16
    s_sub_u32 s65, s2, 256
    s_cmp_lt_u32 s65, 16
    s_cselect_b32 s65, s65, s2
    s_cmp_lt_u32 s2, 256
    s_cselect_b32 s2, s64, s65
    s_cmp_lt_u32 s2, 272
    s_cbranch_scc1 L_B
    s_and_b32 s54, s2, 7
    s_mul_i32 s66, s54, 28
    s_lshr_b32 s64, s2, 3
    s_add_u32 s66, s66, s64
    s_sub_u32 s66, s66, 34
    s_lshl_b32 s64, s66, 10
    v_lshl_add_u32 v24, v0, 1, s64
    s_lshl_b32 s64, s66, 1
    v_lshrrev_b32 v25, 8, v0
    v_add_lshl_u32 v25, v25, s64, 1
    s_waitcnt lgkmcnt(0)
    global_load_short_d16_hi v114, v25, s[14:15]
    global_load_short_d16_hi v4, v24, s[6:7]
    global_load_short_d16_hi v5, v24, s[8:9]
    global_load_short_d16_hi v6, v24, s[10:11]
    global_load_short_d16_hi v7, v24, s[12:13]
    s_branch L_A
L_B:
    v_lshrrev_b32 v4, 6, v0
    v_and_b32 v3, 63, v0
    v_readfirstlane_b32 s3, v4
    v_lshlrev_b32 v7, 4, v3
    s_sub_u32 s58, s2, 16
    s_add_u32 s36, s36, L_tbl-L_pc
    s_addc_u32 s37, s37, 0
    s_mov_b32 s38, 19456
    s_mov_b32 s39, 0x20000
    s_mov_b32 s42, 1835008
    s_mov_b32 s43, 0x20000
    s_cmp_lt_u32 s58, 128
    s_cbranch_scc0 L_pT
    s_mov_b32 s71, s58
    s_lshl_b32 s64, s3, 8
    s_add_u32 s64, s64, s58
    s_mov_b32 s66, 114688
    s_lshl_b32 s65, s3, 11
    s_movk_i32 s67, 1024
    s_waitcnt lgkmcnt(0)
    s_mov_b64 s[40:41], s[18:19]
    s_branch L_pC
L_pT:
    s_sub_u32 s71, s2, 144
    s_lshl_b32 s28, s71, 4
    s_lshl_b32 s64, s2, 7
    s_add_u32 s64, s64, 15
    s_add_u32 s65, s2, 128
    s_cmp_lt_u32 s2, 16
    s_cselect_b32 s28, s64, s28
    s_cselect_b32 s71, s65, s71
    s_cselect_b32 s59, 16, 1
    s_cselect_b32 s66, 0, 7168
    s_mul_i32 s64, s59, s3
    s_add_u32 s64, s64, s28
    s_mul_i32 s65, s3, 1040
    s_movk_i32 s67, 8320
    s_waitcnt lgkmcnt(0)
    s_mov_b64 s[40:41], s[4:5]
L_pC:
    s_mul_i32 s64, s64, 896
    s_mov_b32 m0, s65
    s_add_u32 s66, s66, s64
    buffer_load_dwordx4 v7, s[40:43], s64 offen lds
    s_add_u32 m0, s65, s67
    s_nop 0
    buffer_load_dwordx4 v7, s[40:43], s66 offen lds
    s_mov_b32 s34, 0x10000000
    s_mov_b32 s35, 0x20000
    v_and_b32 v1, 15, v0
    v_bfe_u32 v2, v0, 4, 2
    s_mov_b32 s70, 0
    s_cmp_lt_u32 s58, 128
    s_cbranch_scc0 L_T
    s_mov_b32 s46, 3670016
    s_mov_b32 s47, 0x20000
    s_mov_b32 s50, 921600
    s_mov_b32 s51, 0x20000
    s_mov_b32 s54, 921600
    s_mov_b32 s55, 0x20000
    v_cmp_eq_u32 s[62:63], 15, v1
    s_mov_b64 s[44:45], s[24:25]
    s_mov_b64 s[48:49], s[20:21]
    s_mov_b64 s[52:53], s[22:23]
    s_and_b32 s66, s58, 15
    s_lshr_b32 s67, s58, 4
    v_lshlrev_b32 v10, 2, v1
    v_lshl_add_u32 v24, v2, 19, v10
    v_cvt_f32_u32 v4, v1
    v_lshlrev_b32 v5, 2, v2
    v_cvt_f32_u32 v5, v5
    v_mul_f32 v4, 0x3d800000, v4
    v_cvt_f32_u32 v8, s71
    v_mul_f32 v8, 0x3c000000, v8
    v_add_f32 v13, v5, v8
    v_mul_f32 v13, v13, v4
    v_add_f32 v9, v13, v4
    v_fma_f32 v10, v4, 2.0, v13
    v_add_f32 v11, v10, v4
    v_cos_f32 v96, v13
    v_sin_f32 v100, v13
    v_cos_f32 v97, v9
    v_sin_f32 v101, v9
    v_cos_f32 v98, v10
    v_sin_f32 v102, v10
    v_cos_f32 v99, v11
    v_sin_f32 v103, v11
    v_cvt_pk_bf16_f32 v56, v96, v100
    v_cvt_pk_bf16_f32 v60, -v100, v96
    v_cvt_pk_bf16_f32 v57, v97, v101
    v_cvt_pk_bf16_f32 v61, -v101, v97
    v_cvt_pk_bf16_f32 v58, v98, v102
    v_cvt_pk_bf16_f32 v62, -v102, v98
    v_cvt_pk_bf16_f32 v59, v99, v103
    v_cvt_pk_bf16_f32 v63, -v103, v99
    s_lshl_b32 s64, s3, 10
    s_add_u32 m0, s64, 49664
    s_nop 0
    buffer_load_dwordx4 v7, s[36:39], s64 offen lds
    s_mov_b32 s61, 6488064
    buffer_load_dword v31, off, s[32:35], s61
    v_mul_u32_u24 v25, 5120, v2
    v_mul_u32_u24 v8, 80, v1
    s_lshl_b32 s64, s3, 3
    s_add_u32 s64, s64, 16896
    v_add3_u32 v25, v25, v8, s64
    s_mul_i32 s64, s3, 2560
    s_add_u32 s64, s64, 16896
    v_lshl_add_u32 v26, v2, 4, v8
    v_add_u32 v26, s64, v26
    s_lshl_b32 s65, s3, 11
    v_lshl_add_u32 v120, v3, 3, s65
    s_mul_i32 s64, s67, 56
    s_sub_u32 s65, 896, s64
    s_cmp_lt_u32 s67, 8
    s_cselect_b32 s64, s64, s65
    s_cselect_b32 s65, 2, -2
    v_and_b32 v8, 1, v2
    v_lshrrev_b32 v9, 1, v2
    v_mul_i32_i24 v6, s65, v1
    v_mul_u32_u24 v10, 460800, v8
    v_mul_u32_u24 v11, 7200, v9
    v_add_u32 v6, s64, v6
    v_add3_u32 v6, v6, v10, v11
    s_lshl_b32 s64, s3, 5
    s_add_u32 s64, s64, s66
    s_mul_i32 s68, s64, 450
    s_setprio 3
    s_waitcnt vmcnt(0)
    s_barrier
    ds_read_b64_tr_b16 v[96:97], v120
    ds_read_b64_tr_b16 v[98:99], v120 offset:512
    ds_read_b128 v[32:35], v7 offset:49664
    ds_read_b128 v[36:39], v7 offset:50688
    ds_read_b64_tr_b16 v[100:101], v120 offset:1024
    ds_read_b64_tr_b16 v[102:103], v120 offset:1536
    ds_read_b128 v[48:51], v7 offset:53760
    ds_read_b128 v[52:55], v7 offset:54784
    ds_read_b128 v[40:43], v7 offset:51712
    ds_read_b128 v[44:47], v7 offset:52736
    v_add_u32 v31, 1, v31
    s_nop 0
    v_readfirstlane_b32 s60, v31
    s_waitcnt lgkmcnt(6)
    v_mfma_f32_16x16x32_bf16 v[104:107], v[96:99], v[32:35], 0
    v_mfma_f32_16x16x32_bf16 v[108:111], v[96:99], v[36:39], 0
    s_waitcnt lgkmcnt(4)
    v_mfma_f32_16x16x32_bf16 v[112:115], v[100:103], v[32:35], 0
    v_mfma_f32_16x16x32_bf16 v[116:119], v[100:103], v[36:39], 0
    s_waitcnt lgkmcnt(0)
    s_nop 3
    v_pk_mul_f32 v[8:9], v[108:109], v[52:53]
    v_pk_mul_f32 v[12:13], v[104:105], v[52:53]
    v_pk_mul_f32 v[10:11], v[110:111], v[54:55]
    v_pk_mul_f32 v[14:15], v[106:107], v[54:55]
    v_pk_fma_f32 v[104:105], v[104:105], v[48:49], v[8:9]
    v_pk_fma_f32 v[108:109], v[108:109], v[48:49], v[12:13] neg_lo:[0,0,1] neg_hi:[0,0,1]
    v_pk_fma_f32 v[106:107], v[106:107], v[50:51], v[10:11]
    v_pk_fma_f32 v[110:111], v[110:111], v[50:51], v[14:15] neg_lo:[0,0,1] neg_hi:[0,0,1]
    v_cvt_pk_bf16_f32 v96, v104, v108
    v_cvt_pk_bf16_f32 v97, v105, v109
    v_cvt_pk_bf16_f32 v98, v106, v110
    v_cvt_pk_bf16_f32 v99, v107, v111
    s_nop 1
    v_mfma_f32_16x16x32_bf16 v[104:107], v[40:43], v[96:99], 0
    v_mfma_f32_16x16x32_bf16 v[108:111], v[44:47], v[96:99], 0
    v_pk_mul_f32 v[8:9], v[116:117], v[52:53]
    v_pk_mul_f32 v[12:13], v[112:113], v[52:53]
    v_pk_mul_f32 v[10:11], v[118:119], v[54:55]
    v_pk_mul_f32 v[14:15], v[114:115], v[54:55]
    v_pk_fma_f32 v[112:113], v[112:113], v[48:49], v[8:9]
    v_pk_fma_f32 v[116:117], v[116:117], v[48:49], v[12:13] neg_lo:[0,0,1] neg_hi:[0,0,1]
    v_pk_fma_f32 v[114:115], v[114:115], v[50:51], v[10:11]
    v_pk_fma_f32 v[118:119], v[118:119], v[50:51], v[14:15] neg_lo:[0,0,1] neg_hi:[0,0,1]
    v_cvt_pk_bf16_f32 v100, v112, v116
    v_cvt_pk_bf16_f32 v101, v113, v117
    v_cvt_pk_bf16_f32 v102, v114, v118
    v_cvt_pk_bf16_f32 v103, v115, v119
    s_nop 1
    v_mfma_f32_16x16x32_bf16 v[112:115], v[40:43], v[100:103], 0
    v_mfma_f32_16x16x32_bf16 v[116:119], v[44:47], v[100:103], 0
    v_cvt_pk_bf16_f32 v120, v104, v108
    v_cvt_pk_bf16_f32 v122, v105, v109
    v_cvt_pk_bf16_f32 v124, v106, v110
    v_cvt_pk_bf16_f32 v126, v107, v111
    s_nop 3
    v_cvt_pk_bf16_f32 v121, v112, v116
    v_cvt_pk_bf16_f32 v123, v113, v117
    v_cvt_pk_bf16_f32 v125, v114, v118
    v_cvt_pk_bf16_f32 v127, v115, v119
    ds_write_b64 v25, v[120:121] offset:0
    ds_write_b64 v25, v[122:123] offset:1280
    ds_write_b64 v25, v[124:125] offset:2560
    ds_write_b64 v25, v[126:127] offset:3840
    s_and_b32 s64, s71, 7
    s_lshl_b32 s64, s64, 4
    s_lshr_b32 s65, s71, 3
    s_add_u32 s64, s64, s65
    s_lshl_b32 s64, s64, 6
    s_lshl_b32 s65, s3, 14
    s_add_u32 s64, s64, s65
    s_waitcnt lgkmcnt(0)
    s_barrier
    ds_read_b128 v[96:99], v26
    ds_read_b128 v[100:103], v26 offset:1280
    s_waitcnt lgkmcnt(1)
    v_mfma_f32_16x16x32_bf16 v[104:107], v[56:59], v[96:99], 0
    v_mfma_f32_16x16x32_bf16 v[108:111], v[60:63], v[96:99], 0
    s_waitcnt lgkmcnt(0)
    v_mfma_f32_16x16x32_bf16 v[112:115], v[56:59], v[100:103], 0
    v_mfma_f32_16x16x32_bf16 v[116:119], v[60:63], v[100:103], 0
    s_and_b32 s61, s71, 7
    s_lshl_b32 s61, s61, 10
    s_lshl_b32 s100, s3, 14
    s_add_u32 s61, s61, s100
    s_add_u32 s61, s61, 9437184
    s_add_u32 s76, s32, s61
    s_addc_u32 s77, s33, 0
    s_mov_b32 s100, 63
    s_atomic_inc s100, s[76:77], 0x0
    s_atomic_inc s100, s[76:77], 0x2000
    v_cvt_pk_bf16_f32 v120, v104, v108
    v_cvt_pk_bf16_f32 v121, v105, v109
    v_cvt_pk_bf16_f32 v122, v106, v110
    v_cvt_pk_bf16_f32 v123, v107, v111
    v_cndmask_b32 v120, v120, v31, s[62:63]
    v_cndmask_b32 v121, v121, v31, s[62:63]
    v_cndmask_b32 v122, v122, v31, s[62:63]
    v_cndmask_b32 v123, v123, v31, s[62:63]
    s_add_u32 s65, s64, 65536
    buffer_store_dword v120, v24, s[32:35], s65 offen sc1
    s_add_u32 s65, s64, 196608
    buffer_store_dword v121, v24, s[32:35], s65 offen sc1
    s_add_u32 s65, s64, 327680
    buffer_store_dword v122, v24, s[32:35], s65 offen sc1
    s_add_u32 s65, s64, 458752
    buffer_store_dword v123, v24, s[32:35], s65 offen sc1
    v_cvt_pk_bf16_f32 v124, v112, v116
    v_cvt_pk_bf16_f32 v125, v113, v117
    v_cvt_pk_bf16_f32 v126, v114, v118
    v_cvt_pk_bf16_f32 v127, v115, v119
    v_cndmask_b32 v124, v124, v31, s[62:63]
    v_cndmask_b32 v125, v125, v31, s[62:63]
    v_cndmask_b32 v126, v126, v31, s[62:63]
    v_cndmask_b32 v127, v127, v31, s[62:63]
    s_add_u32 s65, s64, 73728
    buffer_store_dword v124, v24, s[32:35], s65 offen sc1
    s_add_u32 s65, s64, 204800
    buffer_store_dword v125, v24, s[32:35], s65 offen sc1
    s_add_u32 s65, s64, 335872
    buffer_store_dword v126, v24, s[32:35], s65 offen sc1
    s_add_u32 s65, s64, 466944
    buffer_store_dword v127, v24, s[32:35], s65 offen sc1
    s_lshl_b32 s64, s66, 4
    s_add_u32 s64, s64, s67
    s_lshl_b32 s64, s64, 13
    s_lshl_b32 s65, s3, 10
    s_add_u32 s69, s64, s65
    s_add_u32 s69, s69, 65536
    s_barrier
    s_lshl_b32 s64, s3, 10
    s_add_u32 s64, s64, 8192
    s_add_u32 m0, s64, 49664
    s_nop 0
    buffer_load_dwordx4 v7, s[36:39], s64 offen lds
    buffer_load_short_d16_hi v16, v6, s[48:51], s68 offen
    buffer_load_short_d16_hi v20, v6, s[52:55], s68 offen
    s_add_u32 s68, s68, 115200
    buffer_load_short_d16_hi v17, v6, s[48:51], s68 offen
    buffer_load_short_d16_hi v21, v6, s[52:55], s68 offen
    s_add_u32 s68, s68, 115200
    buffer_load_short_d16_hi v18, v6, s[48:51], s68 offen
    buffer_load_short_d16_hi v22, v6, s[52:55], s68 offen
    s_add_u32 s68, s68, 115200
    buffer_load_short_d16_hi v19, v6, s[48:51], s68 offen
    buffer_load_short_d16_hi v23, v6, s[52:55], s68 offen
    s_setprio 0
    v_and_b32 v8, 1, v2
    v_lshrrev_b32 v9, 1, v2
    v_lshlrev_b32 v10, 2, v1
    v_lshl_add_u32 v27, v2, 8, v10
    v_mul_u32_u24 v12, 48, v1
    v_mul_u32_u24 v28, 3072, v2
    v_add_u32 v11, s3, v2
    v_and_b32 v11, 3, v11
    v_lshl_add_u32 v28, v11, 2, v28
    s_and_b32 s64, s3, 4
    s_lshl_b32 s64, s64, 2
    s_add_u32 s64, s64, 37376
    v_add3_u32 v28, v28, v12, s64
    v_mul_u32_u24 v9, 768, v9
    v_lshl_add_u32 v9, v8, 4, v9
    s_mul_i32 s64, s3, 1536
    s_add_u32 s64, s64, 37376
    v_add3_u32 v29, v9, v12, s64
    v_cvt_f32_u32 v8, s3
    v_mul_f32 v8, 0x3e000000, v8
    v_add_f32 v13, v5, v8
    v_mul_f32 v13, v13, v4
    v_fmamk_f32 v12, v8, 0x3d800000, v4
    v_add_f32 v9, v13, v4
    v_fma_f32 v10, v4, 2.0, v13
    v_add_f32 v11, v10, v4
    v_cos_f32 v96, v13
    v_sin_f32 v100, v13
    v_cos_f32 v97, v9
    v_sin_f32 v101, v9
    v_cos_f32 v98, v10
    v_sin_f32 v102, v10
    v_cos_f32 v99, v11
    v_sin_f32 v103, v11
    v_cvt_pk_bf16_f32 v64, v96, v100
    v_cvt_pk_bf16_f32 v68, -v100, v96
    v_cvt_pk_bf16_f32 v65, v97, v101
    v_cvt_pk_bf16_f32 v69, -v101, v97
    v_cvt_pk_bf16_f32 v66, v98, v102
    v_cvt_pk_bf16_f32 v70, -v102, v98
    v_cvt_pk_bf16_f32 v67, v99, v103
    v_cvt_pk_bf16_f32 v71, -v103, v99
    v_mul_f32 v13, v12, v5
    v_add_f32 v9, v13, v12
    v_fma_f32 v10, v12, 2.0, v13
    v_add_f32 v11, v10, v12
    v_cos_f32 v96, v13
    v_sin_f32 v100, v13
    v_cos_f32 v97, v9
    v_sin_f32 v101, v9
    v_cos_f32 v98, v10
    v_sin_f32 v102, v10
    v_cos_f32 v99, v11
    v_sin_f32 v103, v11
    v_cvt_pk_bf16_f32 v72, v96, -v100
    v_cvt_pk_bf16_f32 v76, v100, v96
    v_cvt_pk_bf16_f32 v73, v97, -v101
    v_cvt_pk_bf16_f32 v77, v101, v97
    v_cvt_pk_bf16_f32 v74, v98, -v102
    v_cvt_pk_bf16_f32 v78, v102, v98
    v_cvt_pk_bf16_f32 v75, v99, -v103
    v_cvt_pk_bf16_f32 v79, v103, v99
    s_setprio 3
    s_branch L_col
L_T:
    s_mov_b32 s61, 6488064
    buffer_load_dword v31, off, s[32:35], s61
    s_sub_u32 s61, s2, 256
    s_cmp_ge_u32 s61, 16
    s_cbranch_scc1 L_hz
    s_cmp_lg_u32 s3, 6
    s_cbranch_scc1 L_hz
    s_lshl_b32 s61, s61, 13
    s_add_u32 s61, s61, 9437184
    v_lshrrev_b32 v8, 3, v3
    v_and_b32 v9, 7, v3
    v_lshlrev_b32 v9, 10, v9
    v_lshl_add_u32 v8, v8, 17, v9
    v_mov_b32 v9, 0
    s_mov_b32 exec_lo, 0xff
    s_mov_b32 exec_hi, 0
    buffer_atomic_add v9, v8, s[32:35], s61 offen sc1
    s_mov_b32 exec_lo, 0xffff00
    buffer_store_dword v9, v8, s[32:35], s61 offen sc1
    s_mov_b64 exec, -1
L_hz:
    v_and_b32 v10, 3, v3
    v_lshrrev_b32 v11, 2, v3
    v_cmp_eq_u32 s[56:57], 3, v10
    v_mul_u32_u24 v120, 4160, v10
    v_lshl_add_u32 v120, v11, 2, v120
    s_lshl_b32 s64, s3, 6
    v_add_u32 v120, s64, v120
    v_mul_u32_u24 v121, 9216, v11
    v_lshl_add_u32 v121, v10, 4, v121
    s_mov_b32 s46, 3670016
    s_mov_b32 s47, 0x20000
    s_mov_b32 s50, 921600
    s_mov_b32 s51, 0x20000
    s_mov_b32 s54, 921600
    s_mov_b32 s55, 0x20000
    v_cmp_eq_u32 s[62:63], 15, v1
    s_mov_b64 s[44:45], s[24:25]
    s_mov_b64 s[48:49], s[20:21]
    s_mov_b64 s[52:53], s[22:23]
    s_and_b32 s66, s58, 15
    s_lshr_b32 s67, s58, 4
    v_lshlrev_b32 v10, 2, v1
    v_lshl_add_u32 v24, v2, 19, v10
    v_cvt_f32_u32 v4, v1
    v_lshlrev_b32 v5, 2, v2
    v_cvt_f32_u32 v5, v5
    v_mul_f32 v4, 0x3d800000, v4
    s_mul_i32 s64, s67, 56
    s_sub_u32 s65, 896, s64
    s_cmp_lt_u32 s67, 8
    s_cselect_b32 s64, s64, s65
    s_cselect_b32 s65, 2, -2
    v_and_b32 v8, 1, v2
    v_lshrrev_b32 v9, 1, v2
    v_mul_i32_i24 v6, s65, v1
    v_mul_u32_u24 v10, 460800, v8
    v_mul_u32_u24 v11, 7200, v9
    v_add_u32 v6, s64, v6
    v_add3_u32 v6, v6, v10, v11
    s_lshl_b32 s64, s3, 5
    s_add_u32 s64, s64, s66
    s_mul_i32 s68, s64, 450
    s_mul_i32 s64, s3, 147456
    s_lshl_b32 s65, s71, 6
    s_add_u32 s64, s64, s65
    s_add_u32 s64, s64, 4390912
    s_add_u32 s65, s64, 1179648
    s_setprio 3
    s_waitcnt vmcnt(0)
    s_barrier
    ds_read_b32 v96, v120 offset:0
    ds_read_b32 v97, v120 offset:1040
    ds_read_b32 v98, v120 offset:2080
    ds_read_b32 v99, v120 offset:3120
    ds_read_b32 v100, v120 offset:512
    ds_read_b32 v101, v120 offset:1552
    ds_read_b32 v102, v120 offset:2592
    ds_read_b32 v103, v120 offset:3632
    v_add_u32 v31, 1, v31
    s_nop 0
    v_readfirstlane_b32 s60, v31
    s_waitcnt lgkmcnt(4)
    v_cndmask_b32 v99, v99, v31, s[56:57]
    buffer_store_dwordx4 v[96:99], v121, s[32:35], s64 offen sc1
    s_cmp_ge_u32 s3, 6
    s_cbranch_scc1 L_T_p2
    s_waitcnt lgkmcnt(0)
    v_cndmask_b32 v103, v103, v31, s[56:57]
    buffer_store_dwordx4 v[100:103], v121, s[32:35], s65 offen sc1
L_T_p2:
    s_cmp_lt_u32 s2, 16
    s_cbranch_scc1 L_Ty
    s_lshl_b32 s64, s66, 4
    s_add_u32 s64, s64, s67
    s_lshl_b32 s64, s64, 13
    s_lshl_b32 s65, s3, 10
    s_add_u32 s69, s64, s65
    s_add_u32 s69, s69, 65536
    s_barrier
    s_and_b32 s64, s3, 3
    s_lshl_b32 s64, s64, 10
    s_add_u32 s64, s64, 6144
    s_add_u32 m0, s64, 49664
    s_nop 0
    buffer_load_dwordx4 v7, s[36:39], s64 offen lds
    buffer_load_short_d16_hi v16, v6, s[48:51], s68 offen
    buffer_load_short_d16_hi v20, v6, s[52:55], s68 offen
    s_add_u32 s68, s68, 115200
    buffer_load_short_d16_hi v17, v6, s[48:51], s68 offen
    buffer_load_short_d16_hi v21, v6, s[52:55], s68 offen
    s_add_u32 s68, s68, 115200
    buffer_load_short_d16_hi v18, v6, s[48:51], s68 offen
    buffer_load_short_d16_hi v22, v6, s[52:55], s68 offen
    s_add_u32 s68, s68, 115200
    buffer_load_short_d16_hi v19, v6, s[48:51], s68 offen
    buffer_load_short_d16_hi v23, v6, s[52:55], s68 offen
    s_setprio 0
    v_and_b32 v8, 1, v2
    v_lshrrev_b32 v9, 1, v2
    v_lshlrev_b32 v10, 2, v1
    v_lshl_add_u32 v27, v2, 8, v10
    v_mul_u32_u24 v12, 48, v1
    v_mul_u32_u24 v28, 3072, v2
    v_add_u32 v11, s3, v2
    v_and_b32 v11, 3, v11
    v_lshl_add_u32 v28, v11, 2, v28
    s_and_b32 s64, s3, 4
    s_lshl_b32 s64, s64, 2
    s_add_u32 s64, s64, 37376
    v_add3_u32 v28, v28, v12, s64
    v_mul_u32_u24 v9, 768, v9
    v_lshl_add_u32 v9, v8, 4, v9
    s_mul_i32 s64, s3, 1536
    s_add_u32 s64, s64, 37376
    v_add3_u32 v29, v9, v12, s64
    v_cvt_f32_u32 v8, s3
    v_mul_f32 v8, 0x3e000000, v8
    v_add_f32 v13, v5, v8
    v_mul_f32 v13, v13, v4
    v_fmamk_f32 v12, v8, 0x3d800000, v4
    v_add_f32 v9, v13, v4
    v_fma_f32 v10, v4, 2.0, v13
    v_add_f32 v11, v10, v4
    v_cos_f32 v96, v13
    v_sin_f32 v100, v13
    v_cos_f32 v97, v9
    v_sin_f32 v101, v9
    v_cos_f32 v98, v10
    v_sin_f32 v102, v10
    v_cos_f32 v99, v11
    v_sin_f32 v103, v11
    v_cvt_pk_bf16_f32 v64, v96, v100
    v_cvt_pk_bf16_f32 v68, -v100, v96
    v_cvt_pk_bf16_f32 v65, v97, v101
    v_cvt_pk_bf16_f32 v69, -v101, v97
    v_cvt_pk_bf16_f32 v66, v98, v102
    v_cvt_pk_bf16_f32 v70, -v102, v98
    v_cvt_pk_bf16_f32 v67, v99, v103
    v_cvt_pk_bf16_f32 v71, -v103, v99
    v_mul_f32 v13, v12, v5
    v_add_f32 v9, v13, v12
    v_fma_f32 v10, v12, 2.0, v13
    v_add_f32 v11, v10, v12
    v_cos_f32 v96, v13
    v_sin_f32 v100, v13
    v_cos_f32 v97, v9
    v_sin_f32 v101, v9
    v_cos_f32 v98, v10
    v_sin_f32 v102, v10
    v_cos_f32 v99, v11
    v_sin_f32 v103, v11
    v_cvt_pk_bf16_f32 v72, v96, -v100
    v_cvt_pk_bf16_f32 v76, v100, v96
    v_cvt_pk_bf16_f32 v73, v97, -v101
    v_cvt_pk_bf16_f32 v77, v101, v97
    v_cvt_pk_bf16_f32 v74, v98, -v102
    v_cvt_pk_bf16_f32 v78, v102, v98
    v_cvt_pk_bf16_f32 v75, v99, -v103
    v_cvt_pk_bf16_f32 v79, v103, v99
    s_setprio 3
L_col:
    s_setprio 2
    s_lshr_b32 s64, s3, 1
    s_sub_u32 s65, 0, s64
    s_and_b32 s65, s65, 3
    s_lshl_b32 s65, s65, 8
    v_lshl_add_u32 v52, v3, 2, s65
    s_sub_u32 s65, 1, s64
    s_and_b32 s65, s65, 3
    s_lshl_b32 s65, s65, 8
    v_lshl_add_u32 v53, v3, 2, s65
    s_sub_u32 s65, 2, s64
    s_and_b32 s65, s65, 3
    s_lshl_b32 s65, s65, 8
    v_lshl_add_u32 v54, v3, 2, s65
    s_sub_u32 s65, 3, s64
    s_and_b32 s65, s65, 3
    s_lshl_b32 s65, s65, 8
    v_lshl_add_u32 v55, v3, 2, s65
    v_subrev_u32 v51, s64, v3
    v_and_b32 v51, 3, v51
    v_and_b32 v8, 60, v3
    v_add_lshl_u32 v51, v51, v8, 4
    s_cmp_lg_u32 s3, 0
    s_cbranch_scc1 L_hd_z1
    s_lshr_b32 s61, s58, 3
    s_and_b32 s61, s61, 15
    s_lshl_b32 s61, s61, 13
    s_add_u32 s61, s61, 9437184
    s_add_u32 s24, s32, s61
    s_addc_u32 s25, s33, 0
    s_mov_b32 s101, 0
    s_mov_b32 s72, 0
    s_mov_b32 s73, 0
    s_mov_b32 s74, 0
    s_mov_b32 s75, 0
    s_mov_b32 s76, 0
    s_mov_b32 s77, 0
    s_mov_b32 s78, 0
    s_mov_b32 s79, 0
L_poll_hz1:
    s_add_u32 s61, s72, 1
    s_lshr_b32 s61, s61, 1
    s_cmp_eq_u32 s61, 8
    s_cbranch_scc1 L_hp0_z1
    s_mov_b32 s72, 0
    s_atomic_add s72, s[24:25], 0x0 glc
L_hp0_z1:
    s_add_u32 s61, s73, 1
    s_lshr_b32 s61, s61, 1
    s_cmp_eq_u32 s61, 8
    s_cbranch_scc1 L_hp1_z1
    s_mov_b32 s73, 0
    s_atomic_add s73, s[24:25], 0x400 glc
L_hp1_z1:
    s_add_u32 s61, s74, 1
    s_lshr_b32 s61, s61, 1
    s_cmp_eq_u32 s61, 8
    s_cbranch_scc1 L_hp2_z1
    s_mov_b32 s74, 0
    s_atomic_add s74, s[24:25], 0x800 glc
L_hp2_z1:
    s_add_u32 s61, s75, 1
    s_lshr_b32 s61, s61, 1
    s_cmp_eq_u32 s61, 8
    s_cbranch_scc1 L_hp3_z1
    s_mov_b32 s75, 0
    s_atomic_add s75, s[24:25], 0xc00 glc
L_hp3_z1:
    s_add_u32 s61, s76, 1
    s_lshr_b32 s61, s61, 1
    s_cmp_eq_u32 s61, 8
    s_cbranch_scc1 L_hp4_z1
    s_mov_b32 s76, 0
    s_atomic_add s76, s[24:25], 0x1000 glc
L_hp4_z1:
    s_add_u32 s61, s77, 1
    s_lshr_b32 s61, s61, 1
    s_cmp_eq_u32 s61, 8
    s_cbranch_scc1 L_hp5_z1
    s_mov_b32 s77, 0
    s_atomic_add s77, s[24:25], 0x1400 glc
L_hp5_z1:
    s_add_u32 s61, s78, 1
    s_lshr_b32 s61, s61, 1
    s_cmp_eq_u32 s61, 8
    s_cbranch_scc1 L_hp6_z1
    s_mov_b32 s78, 0
    s_atomic_add s78, s[24:25], 0x1800 glc
L_hp6_z1:
    s_add_u32 s61, s79, 1
    s_lshr_b32 s61, s61, 1
    s_cmp_eq_u32 s61, 8
    s_cbranch_scc1 L_hp7_z1
    s_mov_b32 s79, 0
    s_atomic_add s79, s[24:25], 0x1c00 glc
L_hp7_z1:
    s_add_u32 s101, s101, 1
    s_add_u32 s70, s70, 1
    s_waitcnt lgkmcnt(0)
    s_mov_b32 s100, 0
    s_add_u32 s61, s72, 1
    s_lshr_b32 s61, s61, 1
    s_xor_b32 s61, s61, 8
    s_or_b32 s100, s100, s61
    s_add_u32 s61, s73, 1
    s_lshr_b32 s61, s61, 1
    s_xor_b32 s61, s61, 8
    s_or_b32 s100, s100, s61
    s_add_u32 s61, s74, 1
    s_lshr_b32 s61, s61, 1
    s_xor_b32 s61, s61, 8
    s_or_b32 s100, s100, s61
    s_add_u32 s61, s75, 1
    s_lshr_b32 s61, s61, 1
    s_xor_b32 s61, s61, 8
    s_or_b32 s100, s100, s61
    s_add_u32 s61, s76, 1
    s_lshr_b32 s61, s61, 1
    s_xor_b32 s61, s61, 8
    s_or_b32 s100, s100, s61
    s_add_u32 s61, s77, 1
    s_lshr_b32 s61, s61, 1
    s_xor_b32 s61, s61, 8
    s_or_b32 s100, s100, s61
    s_add_u32 s61, s78, 1
    s_lshr_b32 s61, s61, 1
    s_xor_b32 s61, s61, 8
    s_or_b32 s100, s100, s61
    s_add_u32 s61, s79, 1
    s_lshr_b32 s61, s61, 1
    s_xor_b32 s61, s61, 8
    s_or_b32 s100, s100, s61
    s_cbranch_scc0 L_hd_z1
    s_min_u32 s61, s72, s73
    s_min_u32 s61, s61, s74
    s_min_u32 s61, s61, s75
    s_min_u32 s61, s61, s76
    s_min_u32 s61, s61, s77
    s_min_u32 s61, s61, s78
    s_min_u32 s61, s61, s79
    s_max_u32 s100, s72, s73
    s_max_u32 s100, s100, s74
    s_max_u32 s100, s100, s75
    s_max_u32 s100, s100, s76
    s_max_u32 s100, s100, s77
    s_max_u32 s100, s100, s78
    s_max_u32 s100, s100, s79
    s_cmp_gt_u32 s100, 64
    s_cselect_b32 s61, 0, s61
    s_cmp_ge_u32 s61, 8
    s_cbranch_scc1 L_ad_z1
    s_sleep 16
L_ad_z1:
    s_sleep 1
    s_cmp_lt_u32 s101, 32
    s_cbranch_scc1 L_poll_hz1
L_hd_z1:
    s_waitcnt vmcnt(8)
    s_barrier
    buffer_load_dword v96, v27, s[32:35], s69 offen offset:0 sc1
    buffer_load_dword v97, v27, s[32:35], s69 offen offset:64 sc1
    buffer_load_dword v98, v27, s[32:35], s69 offen offset:128 sc1
    buffer_load_dword v99, v27, s[32:35], s69 offen offset:192 sc1
    ds_read_b32 v32, v52 offset:55808
    ds_read_b32 v36, v52 offset:56832
    ds_read_b32 v33, v53 offset:55808
    ds_read_b32 v37, v53 offset:56832
    ds_read_b32 v34, v54 offset:55808
    ds_read_b32 v38, v54 offset:56832
    ds_read_b32 v35, v55 offset:55808
    ds_read_b32 v39, v55 offset:56832
    ds_read_b128 v[40:43], v51 offset:57856
    ds_read_b128 v[44:47], v51 offset:58880
    s_waitcnt vmcnt(0)
L_chk_z1:
    v_cmp_ne_u32 s[72:73], s60, v96
    v_cmp_ne_u32 s[74:75], s60, v97
    v_cmp_ne_u32 s[76:77], s60, v98
    v_cmp_ne_u32 s[78:79], s60, v99
    s_or_b64 vcc, s[72:73], s[74:75]
    s_or_b64 vcc, vcc, s[76:77]
    s_or_b64 vcc, vcc, s[78:79]
    s_and_b64 vcc, vcc, s[62:63]
    s_cbranch_scc1 L_f_z1
    v_mfma_f32_16x16x32_bf16 v[104:107], v[64:67], v[96:99], 0
    v_mfma_f32_16x16x32_bf16 v[108:111], v[68:71], v[96:99], 0
    s_nop 7
    v_cvt_pk_bf16_f32 v120, v104, v108
    v_cvt_pk_bf16_f32 v121, v105, v109
    v_cvt_pk_bf16_f32 v122, v106, v110
    v_cvt_pk_bf16_f32 v123, v107, v111
    ds_write_b32 v28, v120 offset:0
    ds_write_b32 v28, v121 offset:768
    ds_write_b32 v28, v122 offset:1536
    ds_write_b32 v28, v123 offset:2304
    s_waitcnt lgkmcnt(0)
    s_barrier
    ds_read_b128 v[96:99], v29
    s_waitcnt lgkmcnt(0)
    v_mfma_f32_16x16x32_bf16 v[104:107], v[32:35], v[96:99], 0
    v_mfma_f32_16x16x32_bf16 v[108:111], v[36:39], v[96:99], 0
    s_waitcnt vmcnt(0)
    s_nop 6
    v_mul_f32 v8, v108, v20
    v_mul_f32 v12, v104, v20
    v_mul_f32 v9, v109, v21
    v_mul_f32 v13, v105, v21
    v_mul_f32 v10, v110, v22
    v_mul_f32 v14, v106, v22
    v_mul_f32 v11, v111, v23
    v_mul_f32 v15, v107, v23
    v_fma_f32 v104, v104, v16, -v8
    v_fma_f32 v108, v108, v16, v12
    v_fma_f32 v105, v105, v17, -v9
    v_fma_f32 v109, v109, v17, v13
    v_fma_f32 v106, v106, v18, -v10
    v_fma_f32 v110, v110, v18, v14
    v_fma_f32 v107, v107, v19, -v11
    v_fma_f32 v111, v111, v19, v15
    v_cvt_pk_bf16_f32 v96, v104, v108
    v_cvt_pk_bf16_f32 v97, v105, v109
    v_cvt_pk_bf16_f32 v98, v106, v110
    v_cvt_pk_bf16_f32 v99, v107, v111
    s_nop 1
    v_mfma_f32_16x16x32_bf16 v[104:107], v[40:43], v[96:99], 0
    v_mfma_f32_16x16x32_bf16 v[108:111], v[44:47], v[96:99], 0
    s_nop 7
    v_cvt_pk_bf16_f32 v120, v104, v108
    v_cvt_pk_bf16_f32 v121, v105, v109
    v_cvt_pk_bf16_f32 v122, v106, v110
    v_cvt_pk_bf16_f32 v123, v107, v111
    ds_write_b128 v29, v[120:123]
    s_waitcnt lgkmcnt(0)
    s_barrier
    ds_read_b32 v96, v28 offset:0
    ds_read_b32 v97, v28 offset:768
    ds_read_b32 v98, v28 offset:1536
    ds_read_b32 v99, v28 offset:2304
    s_lshl_b32 s64, s3, 14
    s_lshl_b32 s65, s67, 10
    s_add_u32 s64, s64, s65
    s_lshl_b32 s65, s66, 6
    s_add_u32 s64, s64, s65
    s_waitcnt lgkmcnt(0)
    v_mfma_f32_16x16x32_bf16 v[104:107], v[72:75], v[96:99], 0
    v_mfma_f32_16x16x32_bf16 v[108:111], v[76:79], v[96:99], 0
    s_nop 7
    v_cvt_pk_bf16_f32 v120, v104, v108
    v_cvt_pk_bf16_f32 v121, v105, v109
    v_cvt_pk_bf16_f32 v122, v106, v110
    v_cvt_pk_bf16_f32 v123, v107, v111
    v_cndmask_b32 v120, v120, v31, s[62:63]
    v_cndmask_b32 v121, v121, v31, s[62:63]
    v_cndmask_b32 v122, v122, v31, s[62:63]
    v_cndmask_b32 v123, v123, v31, s[62:63]
    s_add_u32 s65, s64, 2228224
    buffer_store_dword v120, v24, s[32:35], s65 offen sc1
    s_add_u32 s65, s64, 2359296
    buffer_store_dword v121, v24, s[32:35], s65 offen sc1
    s_add_u32 s65, s64, 2490368
    buffer_store_dword v122, v24, s[32:35], s65 offen sc1
    s_add_u32 s65, s64, 2621440
    buffer_store_dword v123, v24, s[32:35], s65 offen sc1
    s_lshr_b32 s73, s67, 1
    s_and_b32 s61, s73, 7
    s_lshl_b32 s61, s61, 10
    s_lshl_b32 s100, s3, 14
    s_add_u32 s61, s61, s100
    s_add_u32 s61, s61, 9568256
    v_lshlrev_b32 v14, 13, v3
    v_mov_b32 v15, 1
    s_mov_b64 exec, 3
    buffer_atomic_add v15, v14, s[32:35], s61 offen sc1
    s_mov_b64 exec, -1
    s_cmp_ge_u32 s2, 144
    s_cbranch_scc1 L_Ty
    s_setprio 0
    s_lshl_b32 s64, s71, 14
    s_lshl_b32 s65, s3, 11
    s_add_u32 s69, s64, s65
    s_add_u32 s69, s69, 2228224
    ds_read_b128 v[32:35], v7 offset:59904
    ds_read_b128 v[36:39], v7 offset:60928
    ds_read_b128 v[40:43], v7 offset:61952
    ds_read_b128 v[44:47], v7 offset:62976
    ds_read_b128 v[48:51], v7 offset:64000
    ds_read_b128 v[52:55], v7 offset:65024
    v_cvt_f32_u32 v8, s71
    v_fmamk_f32 v12, v8, 0x3a000000, v4
    v_mul_f32 v13, v12, v5
    v_add_f32 v9, v13, v12
    v_fma_f32 v10, v12, 2.0, v13
    v_add_f32 v11, v10, v12
    v_cos_f32 v96, v13
    v_sin_f32 v100, v13
    v_cos_f32 v97, v9
    v_sin_f32 v101, v9
    v_cos_f32 v98, v10
    v_sin_f32 v102, v10
    v_cos_f32 v99, v11
    v_sin_f32 v103, v11
    v_cvt_pk_bf16_f32 v80, v96, -v100
    v_cvt_pk_bf16_f32 v84, v100, v96
    v_cvt_pk_bf16_f32 v81, v97, -v101
    v_cvt_pk_bf16_f32 v85, v101, v97
    v_cvt_pk_bf16_f32 v82, v98, -v102
    v_cvt_pk_bf16_f32 v86, v102, v98
    v_cvt_pk_bf16_f32 v83, v99, -v103
    v_cvt_pk_bf16_f32 v87, v103, v99
    v_and_b32 v10, 1, v2
    v_lshl_add_u32 v11, v10, 4, v1
    v_lshlrev_b32 v30, 5, v11
    v_lshrrev_b32 v12, 1, v2
    v_lshl_add_u32 v30, v12, 4, v30
    v_cmp_lt_u32 vcc, 27, v11
    v_mov_b32 v12, 0x10000000
    s_nop 0
    v_cndmask_b32 v30, v30, v12, vcc
    v_lshlrev_b32 v5, 8, v2
    v_lshl_add_u32 v5, v1, 2, v5
    v_cmp_eq_u32 s[28:29], 3, v2
    s_setprio 3
    s_lshr_b32 s61, s71, 3
    s_and_b32 s61, s61, 15
    s_lshl_b32 s61, s61, 3
    s_add_u32 s61, s61, s3
    s_lshl_b32 s61, s61, 10
    s_add_u32 s61, s61, 9568256
    s_add_u32 s24, s32, s61
    s_addc_u32 s25, s33, 0
    s_mov_b32 s101, 0
L_ww_z2:
    s_mov_b32 s72, 0
    s_atomic_add s72, s[24:25], 0 glc
    s_add_u32 s101, s101, 1
    s_waitcnt lgkmcnt(0)
    s_sub_u32 s73, s72, 32
    s_cmp_le_u32 s73, 0
    s_cbranch_scc1 L_wd_z2
    s_sub_u32 s73, s72, 16
    s_cmp_lt_u32 s73, 32
    s_cbranch_scc1 L_wf_z2
    s_sleep 16
L_wf_z2:
    s_sleep 1
    s_cmp_lt_u32 s101, 40
    s_cbranch_scc1 L_ww_z2
L_wd_z2:
    buffer_load_dword v96, v5, s[32:35], s69 offen offset:0 sc1
    buffer_load_dword v97, v5, s[32:35], s69 offen offset:64 sc1
    buffer_load_dword v98, v5, s[32:35], s69 offen offset:128 sc1
    buffer_load_dword v99, v5, s[32:35], s69 offen offset:192 sc1
    buffer_load_dword v100, v5, s[32:35], s69 offen offset:1024 sc1
    buffer_load_dword v101, v5, s[32:35], s69 offen offset:1088 sc1
    buffer_load_dword v102, v5, s[32:35], s69 offen offset:1152 sc1
    buffer_load_dword v103, v5, s[32:35], s69 offen offset:1216 sc1
    s_waitcnt vmcnt(0)
L_chk_z2:
    v_cmp_ne_u32 s[72:73], s60, v96
    v_cmp_ne_u32 s[74:75], s60, v97
    v_cmp_ne_u32 s[76:77], s60, v98
    v_cmp_ne_u32 s[78:79], s60, v99
    v_cmp_ne_u32 s[48:49], s60, v100
    v_cmp_ne_u32 s[50:51], s60, v101
    v_cmp_ne_u32 s[52:53], s60, v102
    v_cmp_ne_u32 s[40:41], s60, v103
    s_or_b64 vcc, s[72:73], s[74:75]
    s_or_b64 vcc, vcc, s[76:77]
    s_or_b64 vcc, vcc, s[78:79]
    s_or_b64 vcc, vcc, s[48:49]
    s_or_b64 vcc, vcc, s[50:51]
    s_or_b64 vcc, vcc, s[52:53]
    s_or_b64 vcc, vcc, s[40:41]
    s_and_b64 vcc, vcc, s[62:63]
    s_cbranch_scc1 L_f_z2
    v_mfma_f32_16x16x32_bf16 v[104:107], v[80:83], v[96:99], 0
    v_mfma_f32_16x16x32_bf16 v[108:111], v[84:87], v[96:99], 0
    v_mfma_f32_16x16x32_bf16 v[112:115], v[80:83], v[100:103], 0
    v_mfma_f32_16x16x32_bf16 v[116:119], v[84:87], v[100:103], 0
    s_nop 5
    v_cvt_pk_bf16_f32 v120, v104, v108
    v_cvt_pk_bf16_f32 v122, v105, v109
    v_cvt_pk_bf16_f32 v124, v106, v110
    v_cvt_pk_bf16_f32 v126, v107, v111
    v_cvt_pk_bf16_f32 v121, v112, v116
    v_cvt_pk_bf16_f32 v123, v113, v117
    v_cvt_pk_bf16_f32 v125, v114, v118
    v_cvt_pk_bf16_f32 v127, v115, v119
    ds_write_b64 v25, v[120:121] offset:0
    ds_write_b64 v25, v[122:123] offset:1280
    ds_write_b64 v25, v[124:125] offset:2560
    ds_write_b64 v25, v[126:127] offset:3840
    s_lshl_b32 s64, s3, 8
    s_add_u32 s64, s64, s71
    s_mul_i32 s64, s64, 1792
    s_add_u32 s64, s64, 896
    s_add_u32 s65, s64, 229376
    s_waitcnt lgkmcnt(0)
    s_barrier
    ds_read_b128 v[96:99], v26
    ds_read_b128 v[100:103], v26 offset:1280
    s_waitcnt lgkmcnt(1)
    v_mfma_f32_16x16x32_bf16 v[104:107], v[96:99], v[32:35], 0
    v_mfma_f32_16x16x32_bf16 v[108:111], v[96:99], v[36:39], 0
    s_waitcnt lgkmcnt(0)
    v_mfma_f32_16x16x32_bf16 v[112:115], v[100:103], v[32:35], 0
    v_mfma_f32_16x16x32_bf16 v[116:119], v[100:103], v[36:39], 0
    s_nop 4
    v_pk_mul_f32 v[8:9], v[108:109], v[44:45]
    v_pk_mul_f32 v[12:13], v[104:105], v[44:45]
    v_pk_mul_f32 v[10:11], v[110:111], v[46:47]
    v_pk_mul_f32 v[14:15], v[106:107], v[46:47]
    v_pk_fma_f32 v[104:105], v[104:105], v[40:41], v[8:9] neg_lo:[0,0,1] neg_hi:[0,0,1]
    v_pk_fma_f32 v[108:109], v[108:109], v[40:41], v[12:13]
    v_pk_fma_f32 v[106:107], v[106:107], v[42:43], v[10:11] neg_lo:[0,0,1] neg_hi:[0,0,1]
    v_pk_fma_f32 v[110:111], v[110:111], v[42:43], v[14:15]
    v_cvt_pk_bf16_f32 v96, v104, v108
    v_cvt_pk_bf16_f32 v97, v105, v109
    v_cvt_pk_bf16_f32 v98, v106, v110
    v_cvt_pk_bf16_f32 v99, v107, v111
    v_cndmask_b32_e64 v99, v99, 0, s[28:29]
    s_nop 1
    v_mfma_f32_16x16x32_bf16 v[104:107], v[96:99], v[48:51], 0
    v_mfma_f32_16x16x32_bf16 v[108:111], v[96:99], v[52:55], 0
    v_pk_mul_f32 v[8:9], v[116:117], v[44:45]
    v_pk_mul_f32 v[12:13], v[112:113], v[44:45]
    v_pk_mul_f32 v[10:11], v[118:119], v[46:47]
    v_pk_mul_f32 v[14:15], v[114:115], v[46:47]
    v_pk_fma_f32 v[112:113], v[112:113], v[40:41], v[8:9] neg_lo:[0,0,1] neg_hi:[0,0,1]
    v_pk_fma_f32 v[116:117], v[116:117], v[40:41], v[12:13]
    v_pk_fma_f32 v[114:115], v[114:115], v[42:43], v[10:11] neg_lo:[0,0,1] neg_hi:[0,0,1]
    v_pk_fma_f32 v[118:119], v[118:119], v[42:43], v[14:15]
    v_cvt_pk_bf16_f32 v100, v112, v116
    v_cvt_pk_bf16_f32 v101, v113, v117
    v_cvt_pk_bf16_f32 v102, v114, v118
    v_cvt_pk_bf16_f32 v103, v115, v119
    v_cndmask_b32_e64 v103, v103, 0, s[28:29]
    s_nop 1
    v_mfma_f32_16x16x32_bf16 v[112:115], v[100:103], v[48:51], 0
    v_mfma_f32_16x16x32_bf16 v[116:119], v[100:103], v[52:55], 0
    v_cvt_pk_bf16_f32 v120, v104, v105
    v_cvt_pk_bf16_f32 v121, v106, v107
    v_cvt_pk_bf16_f32 v122, v108, v109
    v_cvt_pk_bf16_f32 v123, v110, v111
    s_nop 0
    v_permlane16_swap_b32 v120, v122
    v_permlane16_swap_b32 v121, v123
    buffer_store_dwordx4 v[120:123], v30, s[44:47], s64 offen sc1
    v_cvt_pk_bf16_f32 v124, v112, v113
    v_cvt_pk_bf16_f32 v125, v114, v115
    v_cvt_pk_bf16_f32 v126, v116, v117
    v_cvt_pk_bf16_f32 v127, v118, v119
    s_nop 0
    v_permlane16_swap_b32 v124, v126
    v_permlane16_swap_b32 v125, v127
    buffer_store_dwordx4 v[124:127], v30, s[44:47], s65 offen sc1
    s_cmp_ge_u32 s71, 16
    s_cbranch_scc1 L_ra_z1
    s_cmp_lg_u32 s3, 1
    s_cbranch_scc1 L_ra_z1
    s_lshl_b32 s61, s71, 13
    s_add_u32 s61, s61, 9437184
    s_add_u32 s76, s32, s61
    s_addc_u32 s77, s33, 0
    s_mov_b32 s100, -1
    s_atomic_swap s100, s[76:77], 0x0
    s_atomic_swap s100, s[76:77], 0x400
    s_atomic_swap s100, s[76:77], 0x800
    s_atomic_swap s100, s[76:77], 0xc00
    s_atomic_swap s100, s[76:77], 0x1000
    s_atomic_swap s100, s[76:77], 0x1400
    s_atomic_swap s100, s[76:77], 0x1800
    s_atomic_swap s100, s[76:77], 0x1c00
L_ra_z1:
    s_branch L_exit
L_Ty:
    s_setprio 0
    s_mul_i32 s29, s71, 14336
    s_mul_i32 s64, s3, 1792
    s_add_u32 s29, s29, s64
    s_add_u32 s29, s29, 6553600
    s_mul_i32 s72, s59, 1792
    s_cmp_eq_u32 s59, 1
    s_cselect_b32 s59, 105, 56
    s_mul_i32 s28, s28, 1792
    s_mul_i32 s73, s3, 112
    v_mul_u32_u24 v8, 37, v3
    v_lshrrev_b32 v8, 8, v8
    v_mul_u32_u24 v9, 7, v8
    v_sub_u32 v9, v3, v9
    v_add_u32 v10, 64, v3
    v_mul_u32_u24 v11, 147, v10
    v_lshrrev_b32 v11, 10, v11
    v_mul_u32_u24 v12, 7, v11
    v_sub_u32 v12, v10, v12
    v_lshlrev_b32 v9, 4, v9
    v_lshlrev_b32 v12, 4, v12
    v_min_u32 v11, 15, v11
    s_add_u32 s64, s64, 16896
    v_mul_u32_u24 v25, 112, v8
    v_add3_u32 v25, v25, v9, s64
    v_mul_u32_u24 v26, 112, v11
    v_add3_u32 v26, v26, v12, s64
    v_add_u32 v9, s73, v9
    v_add_u32 v12, s73, v12
    global_load_dwordx4 v[112:115], v9, s[16:17]
    global_load_dwordx4 v[116:119], v12, s[16:17]
    v_mul_u32_u24 v104, 1040, v8
    v_add_u32 v104, v104, v9
    v_mul_u32_u24 v108, 1040, v11
    v_add_u32 v108, v108, v12
    ds_read_b128 v[104:107], v104
    ds_read_b128 v[108:111], v108
    v_mul_u32_u24 v48, s72, v8
    v_add_u32 v48, v48, v9
    v_mul_u32_u24 v49, s72, v11
    v_add_u32 v49, v49, v12
    v_mov_b32 v13, 0x10000000
    v_cmp_gt_u32 vcc, s59, v3
    s_nop 1
    v_cndmask_b32 v48, v13, v48, vcc
    v_cmp_gt_u32 vcc, s59, v10
    s_nop 1
    v_cndmask_b32 v49, v13, v49, vcc
    v_and_b32 v10, 3, v3
    v_mul_u32_u24 v10, 448, v10
    v_and_b32 v11, 60, v3
    v_add3_u32 v50, v10, v11, s64
    s_mov_b32 s30, -1
    s_mov_b32 s31, 0xffff
    s_waitcnt vmcnt(0) lgkmcnt(0)
    v_lshlrev_b32 v8, 16, v104
    v_lshlrev_b32 v9, 16, v112
    v_and_b32 v10, 0xffff0000, v104
    v_and_b32 v11, 0xffff0000, v112
    v_mul_f32 v8, v8, v9
    v_mul_f32 v10, v10, v11
    v_cvt_pk_bf16_f32 v8, v8, v10
    v_lshlrev_b32 v80, 16, v8
    v_and_b32 v81, 0xffff0000, v8
    v_lshlrev_b32 v8, 16, v105
    v_lshlrev_b32 v9, 16, v113
    v_and_b32 v10, 0xffff0000, v105
    v_and_b32 v11, 0xffff0000, v113
    v_mul_f32 v8, v8, v9
    v_mul_f32 v10, v10, v11
    v_cvt_pk_bf16_f32 v8, v8, v10
    v_lshlrev_b32 v82, 16, v8
    v_and_b32 v83, 0xffff0000, v8
    v_lshlrev_b32 v8, 16, v106
    v_lshlrev_b32 v9, 16, v114
    v_and_b32 v10, 0xffff0000, v106
    v_and_b32 v11, 0xffff0000, v114
    v_mul_f32 v8, v8, v9
    v_mul_f32 v10, v10, v11
    v_cvt_pk_bf16_f32 v8, v8, v10
    v_lshlrev_b32 v84, 16, v8
    v_and_b32 v85, 0xffff0000, v8
    v_lshlrev_b32 v8, 16, v107
    v_lshlrev_b32 v9, 16, v115
    v_and_b32 v10, 0xffff0000, v107
    v_and_b32 v11, 0xffff0000, v115
    v_mul_f32 v8, v8, v9
    v_mul_f32 v10, v10, v11
    v_cvt_pk_bf16_f32 v8, v8, v10
    v_lshlrev_b32 v86, 16, v8
    v_and_b32 v87, 0xffff0000, v8
    v_lshlrev_b32 v8, 16, v108
    v_lshlrev_b32 v9, 16, v116
    v_and_b32 v10, 0xffff0000, v108
    v_and_b32 v11, 0xffff0000, v116
    v_mul_f32 v8, v8, v9
    v_mul_f32 v10, v10, v11
    v_cvt_pk_bf16_f32 v8, v8, v10
    v_lshlrev_b32 v88, 16, v8
    v_and_b32 v89, 0xffff0000, v8
    v_lshlrev_b32 v8, 16, v109
    v_lshlrev_b32 v9, 16, v117
    v_and_b32 v10, 0xffff0000, v109
    v_and_b32 v11, 0xffff0000, v117
    v_mul_f32 v8, v8, v9
    v_mul_f32 v10, v10, v11
    v_cvt_pk_bf16_f32 v8, v8, v10
    v_lshlrev_b32 v90, 16, v8
    v_and_b32 v91, 0xffff0000, v8
    v_lshlrev_b32 v8, 16, v110
    v_lshlrev_b32 v9, 16, v118
    v_and_b32 v10, 0xffff0000, v110
    v_and_b32 v11, 0xffff0000, v118
    v_mul_f32 v8, v8, v9
    v_mul_f32 v10, v10, v11
    v_cvt_pk_bf16_f32 v8, v8, v10
    v_lshlrev_b32 v92, 16, v8
    v_and_b32 v93, 0xffff0000, v8
    v_lshlrev_b32 v8, 16, v111
    v_lshlrev_b32 v9, 16, v119
    v_and_b32 v10, 0xffff0000, v111
    v_and_b32 v11, 0xffff0000, v119
    v_mul_f32 v8, v8, v9
    v_mul_f32 v10, v10, v11
    v_cvt_pk_bf16_f32 v8, v8, v10
    v_lshlrev_b32 v94, 16, v8
    v_and_b32 v95, 0xffff0000, v8
    v_mov_b32 v103, v31
    s_setprio 3
    s_lshr_b32 s61, s71, 3
    s_and_b32 s61, s61, 15
    s_lshl_b32 s61, s61, 3
    s_add_u32 s61, s61, s3
    s_lshl_b32 s61, s61, 10
    s_add_u32 s61, s61, 9699328
    s_add_u32 s24, s32, s61
    s_addc_u32 s25, s33, 0
    s_mov_b32 s101, 0
    s_cmp_ge_u32 s2, 16
    s_cbranch_scc1 L_dyo
    s_sleep 110
L_dyo:
L_ww_y:
    s_mov_b32 s72, 0
    s_atomic_add s72, s[24:25], 0 glc
    s_add_u32 s101, s101, 1
    s_waitcnt lgkmcnt(0)
    s_sub_u32 s73, s72, 28
    s_cmp_le_u32 s73, 0
    s_cbranch_scc1 L_wd_y
    s_sub_u32 s73, s72, 14
    s_cmp_lt_u32 s73, 28
    s_cbranch_scc1 L_wf_y
    s_sleep 16
L_wf_y:
    s_sleep 1
    s_cmp_lt_u32 s101, 40
    s_cbranch_scc1 L_ww_y
L_wd_y:
    buffer_load_dwordx4 v[96:99], v7, s[32:35], s29 offen sc1
    s_mov_b64 exec, s[30:31]
    buffer_load_dwordx4 v[100:103], v7, s[32:35], s29 offen offset:1024 sc1
    s_mov_b64 exec, -1
    s_waitcnt vmcnt(0)
L_chk_y:
    v_cmp_ne_u32 s[72:73], s60, v99
    v_cmp_ne_u32 s[74:75], s60, v103
    s_nop 0
    s_or_b64 vcc, s[72:73], s[74:75]
    s_and_b64 vcc, vcc, s[56:57]
    s_cbranch_scc1 L_f_y
    ds_write_b32 v50, v96 offset:0
    ds_write_b32 v50, v97 offset:112
    ds_write_b32 v50, v98 offset:224
    ds_write_b32 v50, v99 offset:336
    s_mov_b64 exec, s[30:31]
    ds_write_b32 v50, v100 offset:64
    ds_write_b32 v50, v101 offset:176
    ds_write_b32 v50, v102 offset:288
    ds_write_b32 v50, v103 offset:400
    s_mov_b64 exec, -1
    s_waitcnt lgkmcnt(0)
    ds_read_b128 v[96:99], v25
    ds_read_b128 v[100:103], v26
    s_waitcnt lgkmcnt(1)
    v_lshlrev_b32 v8, 16, v96
    v_and_b32 v9, 0xffff0000, v96
    v_lshlrev_b32 v10, 16, v97
    v_and_b32 v11, 0xffff0000, v97
    v_lshlrev_b32 v12, 16, v98
    v_and_b32 v13, 0xffff0000, v98
    v_lshlrev_b32 v14, 16, v99
    v_and_b32 v15, 0xffff0000, v99
    v_pk_add_f32 v[8:9], v[8:9], v[80:81]
    v_pk_add_f32 v[10:11], v[10:11], v[82:83]
    v_pk_add_f32 v[12:13], v[12:13], v[84:85]
    v_pk_add_f32 v[14:15], v[14:15], v[86:87]
    v_cvt_pk_bf16_f32 v104, v8, v9
    v_cvt_pk_bf16_f32 v105, v10, v11
    v_cvt_pk_bf16_f32 v106, v12, v13
    v_cvt_pk_bf16_f32 v107, v14, v15
    buffer_store_dwordx4 v[104:107], v48, s[44:47], s28 offen
    s_waitcnt lgkmcnt(0)
    v_lshlrev_b32 v8, 16, v100
    v_and_b32 v9, 0xffff0000, v100
    v_lshlrev_b32 v10, 16, v101
    v_and_b32 v11, 0xffff0000, v101
    v_lshlrev_b32 v12, 16, v102
    v_and_b32 v13, 0xffff0000, v102
    v_lshlrev_b32 v14, 16, v103
    v_and_b32 v15, 0xffff0000, v103
    v_pk_add_f32 v[8:9], v[8:9], v[88:89]
    v_pk_add_f32 v[10:11], v[10:11], v[90:91]
    v_pk_add_f32 v[12:13], v[12:13], v[92:93]
    v_pk_add_f32 v[14:15], v[14:15], v[94:95]
    v_cvt_pk_bf16_f32 v108, v8, v9
    v_cvt_pk_bf16_f32 v109, v10, v11
    v_cvt_pk_bf16_f32 v110, v12, v13
    v_cvt_pk_bf16_f32 v111, v14, v15
    buffer_store_dwordx4 v[108:111], v49, s[44:47], s28 offen
    s_cmp_lg_u32 s71, 0
    s_cbranch_scc1 L_noep
    s_barrier
    s_cmp_lg_u32 s3, 0
    s_cbranch_scc1 L_noep
    s_mov_b32 s61, 6488064
    s_mov_b64 exec, 1
    buffer_store_dword v31, off, s[32:35], s61
    s_mov_b64 exec, -1
L_noep:
    s_branch L_exit
L_A:
    s_setprio 1
    v_lshrrev_b32 v32, 6, v0
    v_and_b32 v3, 63, v0
    v_readfirstlane_b32 s3, v32
    v_and_b32 v1, 15, v0
    v_bfe_u32 v2, v0, 4, 2
    s_mov_b32 s70, 0
    s_mov_b32 s34, 0x10000000
    s_mov_b32 s35, 0x20000
    s_mov_b32 s61, 6488064
    buffer_load_dword v115, off, s[32:35], s61
    s_lshr_b32 s67, s3, 2
    s_and_b32 s68, s3, 3
    v_lshlrev_b32 v25, 4, v3
    s_mul_i32 s59, s3, 9216
    v_mul_u32_u24 v24, 288, v1
    v_lshl_add_u32 v24, v2, 4, v24
    v_add_u32 v24, s59, v24
    s_mov_b32 s71, 0x3fb8aa3b
    s_mov_b32 m0, s59
    s_mul_i32 s72, s67, 3072
    s_add_u32 s72, s72, 3072
    s_sub_u32 s64, s72, 32510
    v_lshrrev_b32 v34, 1, v2
    v_and_b32 v35, 1, v2
    s_cmp_eq_u32 s68, 1
    s_cbranch_scc1 L_sc1
    s_cmp_eq_u32 s68, 2
    s_cbranch_scc1 L_sc2
    v_lshlrev_b32 v36, 7, v34
    v_lshl_add_u32 v36, v35, 2, v36
    v_mov_b32 v37, 1
    v_mov_b32 v38, 2
    s_branch L_scd
L_sc1:
    v_lshlrev_b32 v36, 7, v2
    v_add_u32 v36, 256, v36
    v_lshlrev_b32 v37, 8, v2
    v_cmp_lt_u32 vcc, 1, v2
    s_nop 1
    v_cndmask_b32 v36, v36, v37, vcc
    v_cndmask_b32_e64 v37, 2, 4, vcc
    v_mov_b32 v38, 128
    v_cndmask_b32 v38, 4, v38, vcc
    s_branch L_scd
L_sc2:
    v_lshlrev_b32 v36, 9, v2
    v_add_u32 v36, 1024, v36
    v_mov_b32 v37, 128
    v_mov_b32 v38, 256
L_scd:
    v_lshl_add_u32 v36, v1, 3, v36
    v_add_u32 v37, v36, v37
    v_sub_u32 v39, v37, v36
    v_add_u32 v38, v36, v38
    v_add_u32 v39, v38, v39
    v_mov_b32 v34, 2080
    v_cmp_lt_u32 vcc, 2048, v36
    s_nop 1
    v_cndmask_b32 v36, v36, v34, vcc
    v_cmp_lt_u32 vcc, 2048, v37
    s_nop 1
    v_cndmask_b32 v37, v37, v34, vcc
    v_cmp_lt_u32 vcc, 2048, v38
    s_nop 1
    v_cndmask_b32 v38, v38, v34, vcc
    v_cmp_lt_u32 vcc, 2048, v39
    s_nop 1
    v_cndmask_b32 v39, v39, v34, vcc
    v_cvt_f32_u32 v40, v36
    v_cvt_f32_u32 v41, v37
    v_cvt_f32_u32 v42, v38
    v_cvt_f32_u32 v43, v39
    v_cvt_pk_bf16_f32 v40, v40, v41
    v_cvt_pk_bf16_f32 v42, v42, v43
    v_lshlrev_b32 v40, 1, v40
    v_lshlrev_b32 v42, 1, v42
    v_add_u32_sdwa v20, s64, v40 dst_sel:DWORD dst_unused:UNUSED_PAD src0_sel:DWORD src1_sel:WORD_0
    v_add_u32_sdwa v21, s64, v40 dst_sel:DWORD dst_unused:UNUSED_PAD src0_sel:DWORD src1_sel:WORD_1
    v_add_u32_sdwa v22, s64, v42 dst_sel:DWORD dst_unused:UNUSED_PAD src0_sel:DWORD src1_sel:WORD_0
    v_add_u32_sdwa v23, s64, v42 dst_sel:DWORD dst_unused:UNUSED_PAD src0_sel:DWORD src1_sel:WORD_1
    v_max_i32 v20, s72, v20
    s_cmp_lg_u32 s68, 2
    s_cbranch_scc1 L_ng3
    s_mul_i32 s72, s67, 512
    s_add_u32 s72, s72, 35448
    v_lshl_add_u32 v41, v2, 6, v1
    v_lshl_add_u32 v41, v41, 1, s72
    s_mov_b32 exec_hi, 0
    v_add_u32 v21, 32, v41
    v_add_u32 v22, 64, v41
    v_add_u32 v23, 96, v41
    s_mov_b32 exec_lo, -4
    v_mov_b32 v20, v41
    s_mov_b64 exec, -1
L_ng3:
    s_mul_i32 s72, s67, 3072
    s_add_u32 s72, s72, 3072
    s_sub_u32 s64, s72, 32510
    v_and_b32 v33, 255, v0
    v_lshlrev_b32 v33, 3, v33
    v_sub_u32 v33, 2047, v33
    v_cvt_f32_i32 v40, v33
    v_add_f32 v41, 0xbf800000, v40
    v_add_f32 v42, 0xc0000000, v40
    v_add_f32 v43, 0xc0400000, v40
    v_add_f32 v44, 0xc0800000, v40
    v_add_f32 v45, 0xc0a00000, v40
    v_add_f32 v46, 0xc0c00000, v40
    v_add_f32 v47, 0xc0e00000, v40
    v_add_f32 v48, 0xc1000000, v40
    v_mov_b32 v34, 0x45010000
    v_cmp_gt_f32 vcc, 0, v48
    s_nop 1
    v_cndmask_b32 v48, v48, v34, vcc
    v_cvt_pk_bf16_f32 v40, v40, v41
    v_cvt_pk_bf16_f32 v42, v42, v43
    v_cvt_pk_bf16_f32 v44, v44, v45
    v_cvt_pk_bf16_f32 v46, v46, v47
    v_cvt_pk_bf16_f32 v48, v48, v48
    v_lshlrev_b32 v40, 1, v40
    v_lshlrev_b32 v42, 1, v42
    v_lshlrev_b32 v44, 1, v44
    v_lshlrev_b32 v46, 1, v46
    v_lshlrev_b32 v48, 1, v48
    v_add_u32_sdwa v8, s64, v40 dst_sel:DWORD dst_unused:UNUSED_PAD src0_sel:DWORD src1_sel:WORD_0
    v_add_u32_sdwa v9, s64, v40 dst_sel:DWORD dst_unused:UNUSED_PAD src0_sel:DWORD src1_sel:WORD_1
    v_add_u32_sdwa v10, s64, v42 dst_sel:DWORD dst_unused:UNUSED_PAD src0_sel:DWORD src1_sel:WORD_0
    v_add_u32_sdwa v11, s64, v42 dst_sel:DWORD dst_unused:UNUSED_PAD src0_sel:DWORD src1_sel:WORD_1
    v_add_u32_sdwa v12, s64, v44 dst_sel:DWORD dst_unused:UNUSED_PAD src0_sel:DWORD src1_sel:WORD_0
    v_add_u32_sdwa v13, s64, v44 dst_sel:DWORD dst_unused:UNUSED_PAD src0_sel:DWORD src1_sel:WORD_1
    v_add_u32_sdwa v14, s64, v46 dst_sel:DWORD dst_unused:UNUSED_PAD src0_sel:DWORD src1_sel:WORD_0
    v_add_u32_sdwa v15, s64, v46 dst_sel:DWORD dst_unused:UNUSED_PAD src0_sel:DWORD src1_sel:WORD_1
    v_add_u32_sdwa v16, s64, v48 dst_sel:DWORD dst_unused:UNUSED_PAD src0_sel:DWORD src1_sel:WORD_0
    v_max_i32 v15, s72, v15
    v_cmp_eq_u32 s[62:63], 15, v1
    s_mul_i32 s69, s67, 8320
    s_add_u32 s64, s69, 9216
    v_and_b32 v26, 255, v0
    v_lshl_add_u32 v26, v26, 4, s64
    v_add_u32 v34, 1, v1
    v_and_b32 v34, 1, v34
    v_mul_u32_u24 v35, 4158, v34
    v_lshlrev_b32 v36, 4, v2
    v_lshlrev_b32 v37, 1, v1
    v_sub_u32 v36, v36, v37
    s_bfe_u32 s73, s3, 0x10001
    s_and_b32 s64, s3, 1
    s_lshl_b32 s64, s64, 8
    s_mul_i32 s65, s73, 8320
    s_sub_u32 s65, s65, s64
    s_add_u32 s72, s65, 9502
    v_add3_u32 v27, v35, v36, s72
    v_add_u32 v17, 1024, v27
    v_add_u32 v18, 2048, v27
    v_add_u32 v19, 3072, v27
    v_lshlrev_b32 v28, 5, v1
    v_lshl_add_u32 v28, v2, 4, v28
    s_mul_i32 s72, s73, 4608
    s_sub_u32 s72, s72, s64
    s_add_u32 s72, s72, 69376
    v_add_u32 v28, s72, v28
    s_lshl_b32 s64, s3, 9
    s_add_u32 s64, s64, 69600
    v_lshl_add_u32 v30, v3, 3, s64
    v_and_b32 v34, 3, v3
    v_cmp_eq_u32 s[28:29], 3, v34
    v_cmp_gt_u32 vcc, 8, v1
    s_mov_b32 s30, vcc_lo
    s_mov_b32 s31, 0
    s_mov_b32 s52, s62
    s_mov_b32 s53, 0
    v_lshlrev_b32 v35, 8, v2
    v_lshl_add_u32 v35, v1, 5, v35
    s_add_u32 s64, s64, 30
    v_add_u32 v113, s64, v35
    v_lshlrev_b32 v29, 2, v3
    s_mul_i32 s58, s66, 9216
    s_add_u32 s58, s58, 4390912
    s_lshl_b32 s64, s3, 10
    s_add_u32 s57, s58, s64
    s_lshl_b32 s64, s3, 7
    s_add_u32 s55, s58, s64
    s_add_u32 s55, s55, 8192
    s_mov_b32 s50, 0x05040100
    s_mov_b32 s51, 0x07060302
    s_waitcnt vmcnt(1)
    s_cmp_eq_u32 s67, 0
    s_cbranch_scc1 L_bal0
    s_setprio 2
L_bal0:
    v_mul_f32 v34, 0x3fb8aa3b, v114
    v_mul_f32 v36, 0x3fb8aa3b, v4
    v_exp_f32 v31, v34
    v_exp_f32 v32, v36
    v_fma_f32 v35, v114, s71, -v34
    v_fma_f32 v37, v4, s71, -v36
    v_fmac_f32 v35, 0x32a57060, v114
    v_fmac_f32 v37, 0x32a57060, v4
    v_mul_f32 v35, 0x3f317218, v35
    v_mul_f32 v37, 0x3f317218, v37
    v_fma_f32 v31, v31, v35, v31
    v_fma_f32 v32, v32, v37, v32
    v_cvt_pk_bf16_f32 v31, v31, v31
    v_cvt_pk_bf16_f32 v32, v32, v32
    v_and_b32 v31, 0xffff0000, v31
    v_and_b32 v32, 0xffff0000, v32
    v_mul_f32 v33, v5, v31
    v_mul_f32 v32, v32, v31
    v_mul_f32 v33, 0.15915494, v33
    v_mul_f32 v32, 0xbfb8aa3b, v32
    v_add_f32 v31, v31, v31
    v_mul_f32 v35, 0x41000000, v33
    v_mul_f32 v37, 0x43000000, v33
    v_mul_f32 v34, 0x41000000, v32
    v_mul_f32 v36, 0x43000000, v32
    v_fract_f32 v35, v35
    v_fract_f32 v37, v37
    v_fract_f32 v33, v33
    v_exp_f32 v34, v34
    v_cos_f32 v58, v35
    v_sin_f32 v59, v35
    v_exp_f32 v36, v36
    v_cos_f32 v60, v37
    v_sin_f32 v61, v37
    v_exp_f32 v32, v32
    v_cos_f32 v56, v33
    v_sin_f32 v57, v33
    v_mul_f32 v42, v6, v31
    v_mul_f32 v43, v7, v31
    v_mul_f32 v58, v58, v34
    v_mul_f32_e64 v59, v59, -v34
    v_mul_f32 v60, v60, v36
    v_mul_f32 v61, v61, v36
    v_mul_f32 v56, v56, v32
    v_mul_f32 v57, v57, v32
    v_mov_b32 v7, 0x3f80
    ds_write_addtid_b32 v7 offset:0
    v_pk_mul_f32 v[50:51], v[42:43], v[60:61] op_sel:[1,1] op_sel_hi:[1,0] neg_lo:[1,0]
    v_pk_mul_f32 v[52:53], v[58:59], v[58:59] op_sel:[1,1] op_sel_hi:[1,0] neg_lo:[1,0]
    v_pk_fma_f32 v[44:45], v[42:43], v[60:61], v[50:51] op_sel_hi:[0,1,1]
    v_pk_fma_f32 v[110:111], v[58:59], v[58:59], v[52:53] op_sel_hi:[0,1,1]
    v_cvt_pk_bf16_f32 v54, v58, v59
    v_cvt_pk_bf16_f32 v55, v42, v43
    ds_write_addtid_b32 v54 offset:288
    ds_write_addtid_b32 v55 offset:4608
    v_pk_mul_f32 v[48:49], v[44:45], v[60:61] op_sel:[1,1] op_sel_hi:[1,0] neg_lo:[1,0]
    v_pk_mul_f32 v[108:109], v[110:111], v[58:59] op_sel:[1,1] op_sel_hi:[1,0] neg_lo:[1,0]
    v_pk_mul_f32 v[52:53], v[110:111], v[110:111] op_sel:[1,1] op_sel_hi:[1,0] neg_lo:[1,0]
    v_pk_fma_f32 v[34:35], v[44:45], v[60:61], v[48:49] op_sel_hi:[0,1,1]
    v_pk_fma_f32 v[32:33], v[110:111], v[58:59], v[108:109] op_sel_hi:[0,1,1]
    v_pk_fma_f32 v[46:47], v[110:111], v[110:111], v[52:53] op_sel_hi:[0,1,1]
    v_cvt_pk_bf16_f32 v62, v44, v45
    v_cvt_pk_bf16_f32 v63, v110, v111
    v_cvt_pk_bf16_f32 v4, v32, v33
    v_cvt_pk_bf16_f32 v5, v46, v47
    ds_write_addtid_b32 v62 offset:6912
    ds_write_addtid_b32 v63 offset:576
    ds_write_addtid_b32 v4 offset:864
    ds_write_addtid_b32 v5 offset:1152
    v_pk_mul_f32 v[48:49], v[42:43], v[56:57] op_sel:[1,1] op_sel_hi:[1,0] neg_lo:[1,0]
    v_pk_mul_f32 v[50:51], v[44:45], v[56:57] op_sel:[1,1] op_sel_hi:[1,0] neg_lo:[1,0]
    v_pk_mul_f32 v[108:109], v[32:33], v[110:111] op_sel:[1,1] op_sel_hi:[1,0] neg_lo:[1,0]
    v_pk_mul_f32 v[52:53], v[46:47], v[110:111] op_sel:[1,1] op_sel_hi:[1,0] neg_lo:[1,0]
    v_pk_fma_f32 v[42:43], v[42:43], v[56:57], v[48:49] op_sel_hi:[0,1,1]
    v_pk_fma_f32 v[44:45], v[44:45], v[56:57], v[50:51] op_sel_hi:[0,1,1]
    v_pk_fma_f32 v[32:33], v[32:33], v[110:111], v[108:109] op_sel_hi:[0,1,1]
    v_pk_fma_f32 v[46:47], v[46:47], v[110:111], v[52:53] op_sel_hi:[0,1,1]
    v_cvt_pk_bf16_f32 v6, v42, v43
    v_cvt_pk_bf16_f32 v7, v44, v45
    v_cvt_pk_bf16_f32 v54, v32, v33
    v_cvt_pk_bf16_f32 v55, v46, v47
    ds_write_addtid_b32 v6 offset:4896
    ds_write_addtid_b32 v7 offset:7200
    ds_write_addtid_b32 v54 offset:1440
    ds_write_addtid_b32 v55 offset:1728
    v_pk_mul_f32 v[48:49], v[42:43], v[56:57] op_sel:[1,1] op_sel_hi:[1,0] neg_lo:[1,0]
    v_pk_mul_f32 v[50:51], v[44:45], v[56:57] op_sel:[1,1] op_sel_hi:[1,0] neg_lo:[1,0]
    v_pk_mul_f32 v[108:109], v[32:33], v[110:111] op_sel:[1,1] op_sel_hi:[1,0] neg_lo:[1,0]
    v_pk_mul_f32 v[52:53], v[46:47], v[110:111] op_sel:[1,1] op_sel_hi:[1,0] neg_lo:[1,0]
    v_pk_fma_f32 v[42:43], v[42:43], v[56:57], v[48:49] op_sel_hi:[0,1,1]
    v_pk_fma_f32 v[44:45], v[44:45], v[56:57], v[50:51] op_sel_hi:[0,1,1]
    v_pk_fma_f32 v[32:33], v[32:33], v[110:111], v[108:109] op_sel_hi:[0,1,1]
    v_pk_fma_f32 v[46:47], v[46:47], v[110:111], v[52:53] op_sel_hi:[0,1,1]
    v_cvt_pk_bf16_f32 v62, v42, v43
    v_cvt_pk_bf16_f32 v63, v44, v45
    v_cvt_pk_bf16_f32 v4, v32, v33
    v_cvt_pk_bf16_f32 v5, v46, v47
    ds_write_addtid_b32 v62 offset:5184
    ds_write_addtid_b32 v63 offset:7488
    ds_write_addtid_b32 v4 offset:2016
    ds_write_addtid_b32 v5 offset:2304
    v_pk_mul_f32 v[48:49], v[42:43], v[56:57] op_sel:[1,1] op_sel_hi:[1,0] neg_lo:[1,0]
    v_pk_mul_f32 v[50:51], v[44:45], v[56:57] op_sel:[1,1] op_sel_hi:[1,0] neg_lo:[1,0]
    v_pk_mul_f32 v[108:109], v[32:33], v[110:111] op_sel:[1,1] op_sel_hi:[1,0] neg_lo:[1,0]
    v_pk_mul_f32 v[52:53], v[46:47], v[110:111] op_sel:[1,1] op_sel_hi:[1,0] neg_lo:[1,0]
    v_pk_fma_f32 v[42:43], v[42:43], v[56:57], v[48:49] op_sel_hi:[0,1,1]
    v_pk_fma_f32 v[44:45], v[44:45], v[56:57], v[50:51] op_sel_hi:[0,1,1]
    v_pk_fma_f32 v[32:33], v[32:33], v[110:111], v[108:109] op_sel_hi:[0,1,1]
    v_pk_fma_f32 v[46:47], v[46:47], v[110:111], v[52:53] op_sel_hi:[0,1,1]
    v_cvt_pk_bf16_f32 v6, v42, v43
    v_cvt_pk_bf16_f32 v7, v44, v45
    v_cvt_pk_bf16_f32 v54, v32, v33
    v_cvt_pk_bf16_f32 v55, v46, v47
    ds_write_addtid_b32 v6 offset:5472
    ds_write_addtid_b32 v7 offset:7776
    ds_write_addtid_b32 v54 offset:2592
    ds_write_addtid_b32 v55 offset:2880
    v_pk_mul_f32 v[48:49], v[42:43], v[56:57] op_sel:[1,1] op_sel_hi:[1,0] neg_lo:[1,0]
    v_pk_mul_f32 v[50:51], v[44:45], v[56:57] op_sel:[1,1] op_sel_hi:[1,0] neg_lo:[1,0]
    v_pk_mul_f32 v[108:109], v[32:33], v[110:111] op_sel:[1,1] op_sel_hi:[1,0] neg_lo:[1,0]
    v_pk_mul_f32 v[52:53], v[46:47], v[110:111] op_sel:[1,1] op_sel_hi:[1,0] neg_lo:[1,0]
    v_pk_fma_f32 v[42:43], v[42:43], v[56:57], v[48:49] op_sel_hi:[0,1,1]
    v_pk_fma_f32 v[44:45], v[44:45], v[56:57], v[50:51] op_sel_hi:[0,1,1]
    v_pk_fma_f32 v[32:33], v[32:33], v[110:111], v[108:109] op_sel_hi:[0,1,1]
    v_pk_fma_f32 v[46:47], v[46:47], v[110:111], v[52:53] op_sel_hi:[0,1,1]
    v_cvt_pk_bf16_f32 v62, v42, v43
    v_cvt_pk_bf16_f32 v63, v44, v45
    v_cvt_pk_bf16_f32 v4, v32, v33
    v_cvt_pk_bf16_f32 v5, v46, v47
    ds_write_addtid_b32 v62 offset:5760
    ds_write_addtid_b32 v63 offset:8064
    ds_write_addtid_b32 v4 offset:3168
    ds_write_addtid_b32 v5 offset:3456
    v_pk_mul_f32 v[48:49], v[42:43], v[56:57] op_sel:[1,1] op_sel_hi:[1,0] neg_lo:[1,0]
    v_pk_mul_f32 v[50:51], v[44:45], v[56:57] op_sel:[1,1] op_sel_hi:[1,0] neg_lo:[1,0]
    v_pk_mul_f32 v[108:109], v[32:33], v[110:111] op_sel:[1,1] op_sel_hi:[1,0] neg_lo:[1,0]
    v_pk_mul_f32 v[52:53], v[46:47], v[110:111] op_sel:[1,1] op_sel_hi:[1,0] neg_lo:[1,0]
    v_pk_fma_f32 v[42:43], v[42:43], v[56:57], v[48:49] op_sel_hi:[0,1,1]
    v_pk_fma_f32 v[44:45], v[44:45], v[56:57], v[50:51] op_sel_hi:[0,1,1]
    v_pk_fma_f32 v[32:33], v[32:33], v[110:111], v[108:109] op_sel_hi:[0,1,1]
    v_pk_fma_f32 v[46:47], v[46:47], v[110:111], v[52:53] op_sel_hi:[0,1,1]
    v_cvt_pk_bf16_f32 v6, v42, v43
    v_cvt_pk_bf16_f32 v7, v44, v45
    v_cvt_pk_bf16_f32 v54, v32, v33
    v_cvt_pk_bf16_f32 v55, v46, v47
    ds_write_addtid_b32 v6 offset:6048
    ds_write_addtid_b32 v7 offset:8352
    ds_write_addtid_b32 v54 offset:3744
    ds_write_addtid_b32 v55 offset:4032
    v_pk_mul_f32 v[48:49], v[42:43], v[56:57] op_sel:[1,1] op_sel_hi:[1,0] neg_lo:[1,0]
    v_pk_mul_f32 v[50:51], v[44:45], v[56:57] op_sel:[1,1] op_sel_hi:[1,0] neg_lo:[1,0]
    v_pk_mul_f32 v[108:109], v[32:33], v[110:111] op_sel:[1,1] op_sel_hi:[1,0] neg_lo:[1,0]
    v_pk_mul_f32 v[52:53], v[56:57], v[56:57] op_sel:[1,1] op_sel_hi:[1,0] neg_lo:[1,0]
    v_pk_fma_f32 v[42:43], v[42:43], v[56:57], v[48:49] op_sel_hi:[0,1,1]
    v_pk_fma_f32 v[44:45], v[44:45], v[56:57], v[50:51] op_sel_hi:[0,1,1]
    v_pk_fma_f32 v[32:33], v[32:33], v[110:111], v[108:109] op_sel_hi:[0,1,1]
    v_pk_fma_f32 v[38:39], v[56:57], v[56:57], v[52:53] op_sel_hi:[0,1,1]
    v_cvt_pk_bf16_f32 v62, v42, v43
    v_cvt_pk_bf16_f32 v63, v44, v45
    v_cvt_pk_bf16_f32 v4, v32, v33
    ds_write_addtid_b32 v62 offset:6336
    ds_write_addtid_b32 v63 offset:8640
    ds_write_addtid_b32 v4 offset:4320
    v_pk_mul_f32 v[48:49], v[42:43], v[56:57] op_sel:[1,1] op_sel_hi:[1,0] neg_lo:[1,0]
    v_pk_mul_f32 v[50:51], v[44:45], v[56:57] op_sel:[1,1] op_sel_hi:[1,0] neg_lo:[1,0]
    v_pk_mul_f32 v[52:53], v[34:35], v[60:61] op_sel:[1,1] op_sel_hi:[1,0] neg_lo:[1,0]
    v_pk_mul_f32 v[108:109], v[38:39], v[38:39] op_sel:[1,1] op_sel_hi:[1,0] neg_lo:[1,0]
    v_pk_fma_f32 v[42:43], v[42:43], v[56:57], v[48:49] op_sel_hi:[0,1,1]
    v_pk_fma_f32 v[44:45], v[44:45], v[56:57], v[50:51] op_sel_hi:[0,1,1]
    v_pk_fma_f32 v[36:37], v[34:35], v[60:61], v[52:53] op_sel_hi:[0,1,1]
    v_pk_fma_f32 v[40:41], v[38:39], v[38:39], v[108:109] op_sel_hi:[0,1,1]
    v_cvt_pk_bf16_f32 v5, v42, v43
    v_cvt_pk_bf16_f32 v6, v44, v45
    ds_write_addtid_b32 v5 offset:6624
    ds_write_addtid_b32 v6 offset:8928
    s_setprio 1
    s_waitcnt lgkmcnt(0)
    ds_read_b128 v[64:67], v24 offset:0
    ds_read_b128 v[68:71], v24 offset:64
    ds_read_b128 v[72:75], v24 offset:128
    ds_read_b128 v[76:79], v24 offset:192
    ds_read_b128 v[80:83], v24 offset:4608
    ds_read_b128 v[84:87], v24 offset:4672
    ds_read_b128 v[88:91], v24 offset:4736
    ds_read_b128 v[92:95], v24 offset:4800
    v_pk_mul_f32 v[48:49], v[34:35], v[38:39] op_sel:[1,1] op_sel_hi:[1,0] neg_lo:[1,0]
    v_pk_mul_f32 v[50:51], v[36:37], v[38:39] op_sel:[1,1] op_sel_hi:[1,0] neg_lo:[1,0]
    v_pk_mul_f32 v[52:53], v[36:37], v[60:61] op_sel:[1,1] op_sel_hi:[1,0] neg_lo:[1,0]
    v_pk_mul_f32 v[108:109], v[60:61], v[60:61] op_sel:[1,1] op_sel_hi:[1,0] neg_lo:[1,0]
    v_pk_fma_f32 v[42:43], v[34:35], v[38:39], v[48:49] op_sel_hi:[0,1,1]
    v_pk_fma_f32 v[44:45], v[36:37], v[38:39], v[50:51] op_sel_hi:[0,1,1]
    v_pk_fma_f32 v[46:47], v[36:37], v[60:61], v[52:53] op_sel_hi:[0,1,1]
    v_pk_fma_f32 v[110:111], v[60:61], v[60:61], v[108:109] op_sel_hi:[0,1,1]
    s_waitcnt lgkmcnt(4)
    v_cvt_pk_bf16_f32 v7, v34, v35
    v_cvt_pk_bf16_f32 v54, v36, v37
    v_cvt_pk_bf16_f32 v55, v42, v43
    v_cvt_pk_bf16_f32 v62, v44, v45
    v_cvt_pk_bf16_f32 v63, v46, v47
    ds_write_addtid_b32 v7 offset:0
    ds_write_addtid_b32 v54 offset:1152
    ds_write_addtid_b32 v55 offset:288
    ds_write_addtid_b32 v62 offset:1440
    ds_write_addtid_b32 v63 offset:2304
    v_pk_mul_f32 v[48:49], v[42:43], v[38:39] op_sel:[1,1] op_sel_hi:[1,0] neg_lo:[1,0]
    v_pk_mul_f32 v[50:51], v[44:45], v[38:39] op_sel:[1,1] op_sel_hi:[1,0] neg_lo:[1,0]
    v_pk_mul_f32 v[52:53], v[46:47], v[60:61] op_sel:[1,1] op_sel_hi:[1,0] neg_lo:[1,0]
    v_pk_mul_f32 v[108:109], v[46:47], v[40:41] op_sel:[1,1] op_sel_hi:[1,0] neg_lo:[1,0]
    v_pk_fma_f32 v[42:43], v[42:43], v[38:39], v[48:49] op_sel_hi:[0,1,1]
    v_pk_fma_f32 v[44:45], v[44:45], v[38:39], v[50:51] op_sel_hi:[0,1,1]
    v_pk_fma_f32 v[32:33], v[46:47], v[60:61], v[52:53] op_sel_hi:[0,1,1]
    v_pk_fma_f32 v[34:35], v[46:47], v[40:41], v[108:109] op_sel_hi:[0,1,1]
    s_waitcnt lgkmcnt(5)
    v_mfma_f32_16x16x32_bf16 v[96:99], v[80:83], v[64:67], 0
    v_mfma_f32_16x16x32_bf16 v[96:99], v[84:87], v[68:71], v[96:99]
    v_mfma_f32_16x16x32_bf16 v[96:99], v[88:91], v[72:75], v[96:99]
    v_mfma_f32_16x16x32_bf16 v[96:99], v[92:95], v[76:79], v[96:99]
    v_cvt_pk_bf16_f32 v4, v42, v43
    v_cvt_pk_bf16_f32 v5, v44, v45
    v_cvt_pk_bf16_f32 v6, v32, v33
    v_cvt_pk_bf16_f32 v7, v34, v35
    ds_write_addtid_b32 v4 offset:576
    ds_write_addtid_b32 v5 offset:1728
    ds_write_addtid_b32 v6 offset:2880
    ds_write_addtid_b32 v7 offset:2592
    s_waitcnt vmcnt(0)
    v_add_u32 v115, 1, v115
    s_nop 0
    v_readfirstlane_b32 s60, v115
    v_pk_mul_f32 v[48:49], v[42:43], v[38:39] op_sel:[1,1] op_sel_hi:[1,0] neg_lo:[1,0]
    v_pk_mul_f32 v[50:51], v[44:45], v[38:39] op_sel:[1,1] op_sel_hi:[1,0] neg_lo:[1,0]
    v_pk_mul_f32 v[52:53], v[46:47], v[110:111] op_sel:[1,1] op_sel_hi:[1,0] neg_lo:[1,0]
    v_pk_mul_f32 v[108:109], v[32:33], v[40:41] op_sel:[1,1] op_sel_hi:[1,0] neg_lo:[1,0]
    v_pk_fma_f32 v[42:43], v[42:43], v[38:39], v[48:49] op_sel_hi:[0,1,1]
    v_pk_fma_f32 v[44:45], v[44:45], v[38:39], v[50:51] op_sel_hi:[0,1,1]
    v_pk_fma_f32 v[46:47], v[46:47], v[110:111], v[52:53] op_sel_hi:[0,1,1]
    v_pk_fma_f32 v[34:35], v[32:33], v[40:41], v[108:109] op_sel_hi:[0,1,1]
    v_cvt_pk_bf16_f32 v54, v42, v43
    v_cvt_pk_bf16_f32 v55, v44, v45
    v_cvt_pk_bf16_f32 v62, v46, v47
    v_cvt_pk_bf16_f32 v63, v34, v35
    ds_write_addtid_b32 v54 offset:864
    ds_write_addtid_b32 v55 offset:2016
    ds_write_addtid_b32 v62 offset:3456
    ds_write_addtid_b32 v63 offset:3168
    v_pk_mul_f32 v[48:49], v[32:33], v[110:111] op_sel:[1,1] op_sel_hi:[1,0] neg_lo:[1,0]
    v_pk_mul_f32 v[50:51], v[46:47], v[40:41] op_sel:[1,1] op_sel_hi:[1,0] neg_lo:[1,0]
    v_pk_mul_f32 v[52:53], v[46:47], v[110:111] op_sel:[1,1] op_sel_hi:[1,0] neg_lo:[1,0]
    v_pk_fma_f32 v[32:33], v[32:33], v[110:111], v[48:49] op_sel_hi:[0,1,1]
    v_pk_fma_f32 v[34:35], v[46:47], v[40:41], v[50:51] op_sel_hi:[0,1,1]
    v_pk_fma_f32 v[46:47], v[46:47], v[110:111], v[52:53] op_sel_hi:[0,1,1]
    v_cvt_pk_bf16_f32 v4, v32, v33
    v_cvt_pk_bf16_f32 v5, v34, v35
    v_cvt_pk_bf16_f32 v6, v46, v47
    ds_write_addtid_b32 v4 offset:4032
    ds_write_addtid_b32 v5 offset:3744
    ds_write_addtid_b32 v6 offset:4608
    v_pk_mul_f32 v[48:49], v[32:33], v[40:41] op_sel:[1,1] op_sel_hi:[1,0] neg_lo:[1,0]
    v_pk_mul_f32 v[50:51], v[32:33], v[110:111] op_sel:[1,1] op_sel_hi:[1,0] neg_lo:[1,0]
    v_pk_mul_f32 v[52:53], v[46:47], v[110:111] op_sel:[1,1] op_sel_hi:[1,0] neg_lo:[1,0]
    v_pk_fma_f32 v[36:37], v[32:33], v[40:41], v[48:49] op_sel_hi:[0,1,1]
    v_pk_fma_f32 v[32:33], v[32:33], v[110:111], v[50:51] op_sel_hi:[0,1,1]
    v_pk_fma_f32 v[46:47], v[46:47], v[110:111], v[52:53] op_sel_hi:[0,1,1]
    v_cvt_pk_bf16_f32 v7, v36, v37
    v_cvt_pk_bf16_f32 v54, v32, v33
    v_cvt_pk_bf16_f32 v55, v46, v47
    ds_write_addtid_b32 v7 offset:4320
    ds_write_addtid_b32 v54 offset:4896
    ds_write_addtid_b32 v55 offset:5184
    s_waitcnt lgkmcnt(2)
    ds_read_b128 v[80:83], v24 offset:0
    ds_read_b128 v[84:87], v24 offset:64
    ds_read_b128 v[88:91], v24 offset:128
    ds_read_b128 v[92:95], v24 offset:192
    v_pk_mul_f32 v[48:49], v[32:33], v[110:111] op_sel:[1,1] op_sel_hi:[1,0] neg_lo:[1,0]
    v_pk_mul_f32 v[50:51], v[46:47], v[110:111] op_sel:[1,1] op_sel_hi:[1,0] neg_lo:[1,0]
    v_pk_fma_f32 v[32:33], v[32:33], v[110:111], v[48:49] op_sel_hi:[0,1,1]
    v_pk_fma_f32 v[46:47], v[46:47], v[110:111], v[50:51] op_sel_hi:[0,1,1]
    v_cvt_pk_bf16_f32 v62, v32, v33
    v_cvt_pk_bf16_f32 v63, v46, v47
    ds_write_addtid_b32 v62 offset:5472
    ds_write_addtid_b32 v63 offset:5760
    v_pk_mul_f32 v[48:49], v[32:33], v[110:111] op_sel:[1,1] op_sel_hi:[1,0] neg_lo:[1,0]
    v_pk_mul_f32 v[50:51], v[46:47], v[110:111] op_sel:[1,1] op_sel_hi:[1,0] neg_lo:[1,0]
    v_pk_fma_f32 v[32:33], v[32:33], v[110:111], v[48:49] op_sel_hi:[0,1,1]
    v_pk_fma_f32 v[46:47], v[46:47], v[110:111], v[50:51] op_sel_hi:[0,1,1]
    v_cvt_pk_bf16_f32 v4, v32, v33
    v_cvt_pk_bf16_f32 v5, v46, v47
    ds_write_addtid_b32 v4 offset:6048
    ds_write_addtid_b32 v5 offset:6336
    s_waitcnt lgkmcnt(4)
    v_mfma_f32_16x16x32_bf16 v[100:103], v[80:83], v[64:67], 0
    v_mfma_f32_16x16x32_bf16 v[100:103], v[84:87], v[68:71], v[100:103]
    v_mfma_f32_16x16x32_bf16 v[100:103], v[88:91], v[72:75], v[100:103]
    v_mfma_f32_16x16x32_bf16 v[100:103], v[92:95], v[76:79], v[100:103]
    v_pk_mul_f32 v[48:49], v[32:33], v[110:111] op_sel:[1,1] op_sel_hi:[1,0] neg_lo:[1,0]
    v_pk_mul_f32 v[50:51], v[46:47], v[110:111] op_sel:[1,1] op_sel_hi:[1,0] neg_lo:[1,0]
    v_pk_fma_f32 v[32:33], v[32:33], v[110:111], v[48:49] op_sel_hi:[0,1,1]
    v_pk_fma_f32 v[46:47], v[46:47], v[110:111], v[50:51] op_sel_hi:[0,1,1]
    v_cvt_pk_bf16_f32 v6, v32, v33
    v_cvt_pk_bf16_f32 v7, v46, v47
    ds_write_addtid_b32 v6 offset:6624
    ds_write_addtid_b32 v7 offset:6912
    s_waitcnt lgkmcnt(0)
    ds_read_b128 v[80:83], v24 offset:4608
    ds_read_b128 v[84:87], v24 offset:4672
    ds_read_b128 v[88:91], v24 offset:4736
    ds_read_b128 v[92:95], v24 offset:4800
    v_add_u32 v32, s59, v25
    ds_write_b128 v32, v[96:99]
    ds_write_b128 v32, v[100:103] offset:1024
    s_waitcnt lgkmcnt(2)
    v_mfma_f32_16x16x32_bf16 v[104:107], v[80:83], v[64:67], 0
    v_mfma_f32_16x16x32_bf16 v[104:107], v[84:87], v[68:71], v[104:107]
    v_mfma_f32_16x16x32_bf16 v[104:107], v[88:91], v[72:75], v[104:107]
    v_mfma_f32_16x16x32_bf16 v[104:107], v[92:95], v[76:79], v[104:107]
    s_nop 7
    ds_write_b128 v32, v[104:107] offset:2048
    s_waitcnt lgkmcnt(0)
    s_barrier
    s_setprio 3
    buffer_load_dwordx4 v[116:119], v25, s[32:35], s57 offen sc1
    s_mov_b32 exec_hi, 0
    buffer_load_dword v120, v29, s[32:35], s55 offen sc1
    s_mov_b64 exec, -1
    s_cmp_eq_u32 s68, 3
    s_cbranch_scc1 L_zp
    s_lshl_b32 s72, s68, 10
    s_mul_i32 s73, s67, 36864
    s_add_u32 s72, s72, s73
    v_add_u32 v32, s72, v25
    ds_read_b128 v[96:99], v32
    ds_read_b128 v[100:103], v32 offset:9216
    ds_read_b128 v[104:107], v32 offset:18432
    ds_read_b128 v[80:83], v32 offset:27648
    s_waitcnt lgkmcnt(2)
    v_pk_add_f32 v[96:97], v[96:97], v[100:101]
    v_pk_add_f32 v[98:99], v[98:99], v[102:103]
    s_waitcnt lgkmcnt(0)
    v_pk_add_f32 v[104:105], v[104:105], v[80:81]
    v_pk_add_f32 v[106:107], v[106:107], v[82:83]
    v_pk_add_f32 v[96:97], v[96:97], v[104:105]
    v_pk_add_f32 v[98:99], v[98:99], v[106:107]
    v_cvt_pk_bf16_f32 v96, v96, v97
    v_cvt_pk_bf16_f32 v98, v98, v99
    ds_write_b16 v20, v96
    ds_write_b16_d16_hi v21, v96
    ds_write_b16 v22, v98
    ds_write_b16_d16_hi v23, v98
    s_branch L_zpd
L_zp:
    v_mov_b32 v96, 0
    v_mov_b32 v97, 0
    v_mov_b32 v98, 0
    v_mov_b32 v99, 0
    s_mul_i32 s72, s67, 3072
    s_add_u32 s72, s72, 5892
    v_mov_b32 v33, s72
    ds_write_b16 v33, v96
    s_sub_u32 s72, s72, 254
    v_min_u32 v33, 62, v3
    v_lshl_add_u32 v33, v33, 1, s72
    ds_write_b16 v33, v96
    ds_write_b16 v33, v96 offset:126
    s_mul_i32 s72, s67, 512
    s_add_u32 s72, s72, 35328
    v_cmp_eq_u32 vcc, 31, v3
    s_nop 1
    v_cndmask_b32_e64 v33, v3, 47, vcc
    v_cndmask_b32_e64 v65, 0, 47, vcc
    v_add_u32 v33, v33, v65
    v_lshl_add_u32 v33, v33, 2, s72
    s_mov_b32 exec_hi, 0
    ds_write_b32 v33, v96
    s_mov_b64 exec, -1
    s_mul_i32 s72, s67, 4608
    s_add_u32 s72, s72, 69120
    v_add_u32 v33, s72, v25
    s_mov_b64 exec, 0x3fffffff
    ds_write_b128 v33, v[96:99]
    s_mov_b64 exec, -1
    v_lshrrev_b32 v64, 1, v3
    v_mul_u32_u24 v64, 4160, v64
    v_and_b32 v65, 1, v3
    v_lshl_add_u32 v64, v65, 4, v64
    s_add_u32 s72, s69, 13312
    v_add_u32 v64, s72, v64
L_zpd:
    s_waitcnt lgkmcnt(0)
    s_barrier
    ds_read_u16 v32, v8
    ds_read_u16 v33, v9
    ds_read_u16 v34, v10
    ds_read_u16 v35, v11
    ds_read_u16 v36, v12
    ds_read_u16 v37, v13
    ds_read_u16 v38, v14
    ds_read_u16 v39, v15
    ds_read_u16 v40, v16
    s_cmp_lg_u32 s68, 3
    s_cbranch_scc1 L_nzt
    s_mov_b64 exec, 0xf
    ds_write_b128 v64, v[96:99]
    s_mov_b64 exec, -1
L_nzt:
    s_waitcnt lgkmcnt(0)
    v_lshl_or_b32 v48, v33, 16, v32
    v_lshl_or_b32 v49, v35, 16, v34
    v_lshl_or_b32 v50, v37, 16, v36
    v_lshl_or_b32 v51, v39, 16, v38
    ds_write_b128 v26, v[48:51] offset:0
    v_lshl_or_b32 v52, v34, 16, v33
    v_lshl_or_b32 v53, v36, 16, v35
    v_lshl_or_b32 v54, v38, 16, v37
    v_lshl_or_b32 v55, v40, 16, v39
    ds_write_b128 v26, v[52:55] offset:4160
    s_waitcnt vmcnt(0)
L_chk_u:
    v_cmp_ne_u32 s[72:73], s60, v119
    v_cmp_ne_u32 s[74:75], s60, v120
    s_and_b64 s[72:73], s[72:73], s[28:29]
    s_and_b64 s[74:75], s[74:75], s[52:53]
    s_or_b64 vcc, s[72:73], s[74:75]
    s_cbranch_scc1 L_f_u
    v_perm_b32 v56, v117, v116, s50
    v_perm_b32 v57, v119, v118, s50
    v_perm_b32 v58, v117, v116, s51
    v_perm_b32 v59, v119, v118, s51
    s_andn2_b64 exec, -1, s[28:29]
    ds_write_b64 v30, v[56:57]
    ds_write_b64 v30, v[58:59] offset:4608
    s_mov_b64 exec, s[28:29]
    ds_write_b32 v30, v56
    ds_write_b16 v30, v57 offset:4
    ds_write_b32 v30, v58 offset:4608
    ds_write_b16 v30, v59 offset:4612
    s_mov_b64 exec, s[30:31]
    ds_write_b16 v113, v120
    ds_write_b16_d16_hi v113, v120 offset:4608
    s_mov_b64 exec, -1
    s_cmp_ge_u32 s3, 4
    s_cbranch_scc1 L_nbm
    s_add_u32 s36, s36, L_tbl-L_pc+16384
    s_addc_u32 s37, s37, 0
    global_load_dwordx4 v[116:119], v25, s[36:37]
    global_load_dwordx4 v[120:123], v25, s[36:37] offset:1024
    global_load_dwordx4 v[124:127], v25, s[36:37] offset:2048
L_nbm:
    s_waitcnt lgkmcnt(0)
    s_barrier
    s_setprio 1
    s_cmp_lt_u32 s3, 4
    s_cbranch_scc1 L_conv
    v_lshrrev_b32 v5, 3, v3
    v_xor_b32 v5, v5, v3
    v_and_b32 v5, 3, v5
    v_lshlrev_b32 v5, 4, v5
    v_and_b32 v6, 0x3c, v3
    v_lshl_add_u32 v5, v6, 4, v5
    s_lshl_b32 s64, s3, 10
    v_add_u32 v5, s64, v5
    v_lshrrev_b32 v6, 2, v3
    v_mul_u32_u24 v6, 14336, v6
    v_and_b32 v7, 3, v3
    v_lshl_add_u32 v6, v7, 4, v6
    s_mul_i32 s64, s3, 229376
    s_lshl_b32 s65, s66, 6
    s_add_u32 s64, s64, s65
    s_add_u32 s64, s64, 6553600
    v_cmp_eq_u32 s[56:57], 3, v7
    v_mov_b32 v11, s60
    v_and_b32 v9, 7, v1
    v_and_b32 v12, 1, v2
    v_lshl_add_u32 v9, v12, 3, v9
    v_lshrrev_b32 v12, 1, v9
    v_and_b32 v12, 3, v12
    v_xor_b32 v12, 3, v12
    v_lshlrev_b32 v12, 4, v12
    v_lshl_add_u32 v9, v9, 6, v12
    s_lshl_b32 s72, s3, 10
    s_add_u32 s72, s72, 12
    v_add_u32 v9, s72, v9
    v_mul_u32_u24 v10, 14336, v2
    v_lshl_add_u32 v10, v1, 2, v10
    s_mul_i32 s72, s3, 28672
    s_add_u32 s65, s65, s72
    s_add_u32 s65, s65, 8388608
    s_branch L_tC
L_conv:
    ds_read2_b32 v[64:65], v19 offset0:176 offset1:177
    ds_read2_b32 v[66:67], v19 offset0:178 offset1:179
    ds_read_b128 v[68:71], v28 offset:192
    ds_read2_b32 v[72:73], v19 offset0:48 offset1:49
    ds_read2_b32 v[74:75], v19 offset0:50 offset1:51
    ds_read2_b32 v[76:77], v18 offset0:176 offset1:177
    ds_read2_b32 v[78:79], v18 offset0:178 offset1:179
    ds_read2_b32 v[80:81], v18 offset0:48 offset1:49
    ds_read2_b32 v[82:83], v18 offset0:50 offset1:51
    ds_read2_b32 v[84:85], v17 offset0:176 offset1:177
    ds_read2_b32 v[86:87], v17 offset0:178 offset1:179
    ds_read_b128 v[88:91], v28 offset:704
    ds_read_b128 v[92:95], v28 offset:1216
    s_waitcnt lgkmcnt(10)
    v_mfma_f32_16x16x32_bf16 v[32:35], v[64:67], v[68:71], 0
    ds_read_b128 v[96:99], v28 offset:1728
    s_waitcnt lgkmcnt(9)
    v_mfma_f32_16x16x32_bf16 v[36:39], v[72:75], v[68:71], 0
    ds_read_b128 v[100:103], v28 offset:2240
    s_waitcnt lgkmcnt(8)
    v_mfma_f32_16x16x32_bf16 v[40:43], v[76:79], v[68:71], 0
    ds_read_b128 v[104:107], v28 offset:2752
    s_waitcnt lgkmcnt(7)
    v_mfma_f32_16x16x32_bf16 v[44:47], v[80:83], v[68:71], 0
    ds_read_b128 v[108:111], v28 offset:3264
    s_waitcnt lgkmcnt(6)
    v_mfma_f32_16x16x32_bf16 v[48:51], v[84:87], v[68:71], 0
    ds_read_b128 v[112:115], v28 offset:3776
    s_waitcnt lgkmcnt(6)
    v_mfma_f32_16x16x32_bf16 v[36:39], v[64:67], v[88:91], v[36:39]
    ds_read2_b32 v[68:69], v19 offset0:160 offset1:161
    v_mfma_f32_16x16x32_bf16 v[40:43], v[72:75], v[88:91], v[40:43]
    ds_read2_b32 v[70:71], v19 offset0:162 offset1:163
    v_mfma_f32_16x16x32_bf16 v[44:47], v[76:79], v[88:91], v[44:47]
    v_lshlrev_b32 v14, 5, v1
    v_mfma_f32_16x16x32_bf16 v[48:51], v[80:83], v[88:91], v[48:51]
    v_lshl_add_u32 v14, v2, 4, v14
    s_bfe_u32 s73, s3, 0x10001
    v_mfma_f32_16x16x32_bf16 v[52:55], v[84:87], v[88:91], 0
    ds_read_b128 v[88:91], v28 offset:128
    s_waitcnt lgkmcnt(5)
    v_mfma_f32_16x16x32_bf16 v[40:43], v[64:67], v[92:95], v[40:43]
    s_and_b32 s72, s3, 1
    s_lshl_b32 s64, s72, 9
    v_mfma_f32_16x16x32_bf16 v[44:47], v[72:75], v[92:95], v[44:47]
    s_lshl_b32 s72, s72, 6
    s_mul_i32 s65, s73, 4608
    v_mfma_f32_16x16x32_bf16 v[48:51], v[76:79], v[92:95], v[48:51]
    s_add_u32 s64, s64, s65
    s_add_u32 s64, s64, 69536
    v_mfma_f32_16x16x32_bf16 v[52:55], v[80:83], v[92:95], v[52:55]
    v_add_u32 v14, s64, v14
    v_mfma_f32_16x16x32_bf16 v[56:59], v[84:87], v[92:95], 0
    ds_read2_b32 v[92:93], v19 offset0:32 offset1:33
    v_mfma_f32_16x16x32_bf16 v[44:47], v[64:67], v[96:99], v[44:47]
    ds_read2_b32 v[94:95], v19 offset0:34 offset1:35
    v_mfma_f32_16x16x32_bf16 v[48:51], v[72:75], v[96:99], v[48:51]
    v_lshlrev_b32 v15, 2, v2
    v_mfma_f32_16x16x32_bf16 v[52:55], v[76:79], v[96:99], v[52:55]
    v_sub_u32 v15, v1, v15
    s_mul_i32 s64, s73, 512
    v_mfma_f32_16x16x32_bf16 v[56:59], v[80:83], v[96:99], v[56:59]
    s_sub_u32 s64, s64, s72
    s_add_u32 s64, s64, 35440
    v_mfma_f32_16x16x32_bf16 v[60:63], v[84:87], v[96:99], 0
    ds_read2_b32 v[84:85], v18 offset0:160 offset1:161
    v_mfma_f32_16x16x32_bf16 v[48:51], v[64:67], v[100:103], v[48:51]
    ds_read2_b32 v[86:87], v18 offset0:162 offset1:163
    v_mfma_f32_16x16x32_bf16 v[52:55], v[72:75], v[100:103], v[52:55]
    ds_read2_b32 v[96:97], v18 offset0:32 offset1:33
    v_mfma_f32_16x16x32_bf16 v[56:59], v[76:79], v[100:103], v[56:59]
    ds_read2_b32 v[98:99], v18 offset0:34 offset1:35
    v_mfma_f32_16x16x32_bf16 v[60:63], v[80:83], v[100:103], v[60:63]
    v_lshl_add_u32 v15, v15, 2, s64
    v_mfma_f32_16x16x32_bf16 v[52:55], v[64:67], v[104:107], v[52:55]
    ds_read_b128 v[80:83], v14 offset:0
    v_mfma_f32_16x16x32_bf16 v[56:59], v[72:75], v[104:107], v[56:59]
    v_lshrrev_b32 v4, 1, v1
    v_mfma_f32_16x16x32_bf16 v[60:63], v[76:79], v[104:107], v[60:63]
    ds_read_b128 v[104:107], v14 offset:64
    s_waitcnt lgkmcnt(5)
    v_mfma_f32_16x16x32_bf16 v[56:59], v[64:67], v[108:111], v[56:59]
    v_and_b32 v4, 3, v4
    v_mfma_f32_16x16x32_bf16 v[60:63], v[72:75], v[108:111], v[60:63]
    ds_read_b128 v[72:75], v28 offset:640
    v_mfma_f32_16x16x32_bf16 v[60:63], v[64:67], v[112:115], v[60:63]
    ds_read_b128 v[108:111], v14 offset:1024
    v_mfma_f32_16x16x32_bf16 v[32:35], v[68:71], v[88:91], v[32:35]
    v_xor_b32 v4, v4, v2
    v_mfma_f32_16x16x32_bf16 v[36:39], v[92:95], v[88:91], v[36:39]
    v_lshlrev_b32 v4, 4, v4
    s_waitcnt lgkmcnt(3)
    v_mfma_f32_16x16x32_bf16 v[40:43], v[84:87], v[88:91], v[40:43]
    v_lshl_add_u32 v4, v1, 6, v4
    s_lshl_b32 s64, s3, 13
    v_mfma_f32_16x16x32_bf16 v[44:47], v[96:99], v[88:91], v[44:47]
    ds_read_b128 v[88:91], v14 offset:1088
    s_waitcnt vmcnt(0)
    v_mfma_f32_16x16x32_bf16 v[100:103], v[80:83], v[116:119], 0
    s_add_u32 s65, s64, 34816
    s_cmp_eq_u32 s3, 0
    v_mfma_f32_16x16x32_bf16 v[76:79], v[80:83], v[124:127], 0
    ds_read_b128 v[80:83], v28 offset:1152
    s_waitcnt lgkmcnt(2)
    v_mfma_f32_16x16x32_bf16 v[100:103], v[104:107], v[120:123], v[100:103]
    ds_read_b128 v[104:107], v28 offset:1664
    v_mfma_f32_16x16x32_bf16 v[36:39], v[68:71], v[72:75], v[36:39]
    s_cselect_b32 s64, 0, s65
    v_mfma_f32_16x16x32_bf16 v[40:43], v[92:95], v[72:75], v[40:43]
    v_add_u32 v4, s64, v4
    v_mfma_f32_16x16x32_bf16 v[44:47], v[84:87], v[72:75], v[44:47]
    v_lshrrev_b32 v5, 3, v3
    v_mfma_f32_16x16x32_bf16 v[48:51], v[96:99], v[72:75], v[48:51]
    ds_read_b128 v[72:75], v28 offset:2176
    v_mfma_f32_16x16x32_bf16 v[64:67], v[108:111], v[116:119], 0
    v_xor_b32 v5, v5, v3
    v_mfma_f32_16x16x32_bf16 v[112:115], v[108:111], v[124:127], 0
    ds_read_b128 v[108:111], v28 offset:2688
    s_waitcnt lgkmcnt(3)
    v_mfma_f32_16x16x32_bf16 v[64:67], v[88:91], v[120:123], v[64:67]
    ds_read_b128 v[88:91], v28 offset:3200
    v_mfma_f32_16x16x32_bf16 v[40:43], v[68:71], v[80:83], v[40:43]
    v_and_b32 v5, 3, v5
    v_mfma_f32_16x16x32_bf16 v[44:47], v[92:95], v[80:83], v[44:47]
    v_lshlrev_b32 v5, 4, v5
    v_mfma_f32_16x16x32_bf16 v[48:51], v[84:87], v[80:83], v[48:51]
    v_and_b32 v6, 0x3c, v3
    v_mfma_f32_16x16x32_bf16 v[52:55], v[96:99], v[80:83], v[52:55]
    ds_read_b128 v[80:83], v28 offset:3712
    s_waitcnt lgkmcnt(3)
    v_mfma_f32_16x16x32_bf16 v[44:47], v[68:71], v[104:107], v[44:47]
    v_cvt_pk_bf16_f32 v100, v100, v76
    v_mfma_f32_16x16x32_bf16 v[48:51], v[92:95], v[104:107], v[48:51]
    v_cvt_pk_bf16_f32 v101, v101, v77
    v_mfma_f32_16x16x32_bf16 v[52:55], v[84:87], v[104:107], v[52:55]
    v_cvt_pk_bf16_f32 v102, v102, v78
    v_mfma_f32_16x16x32_bf16 v[56:59], v[96:99], v[104:107], v[56:59]
    ds_read2_b32 v[104:105], v19 offset0:144 offset1:145
    v_cvt_pk_bf16_f32 v103, v103, v79
    v_mfma_f32_16x16x32_bf16 v[48:51], v[68:71], v[72:75], v[48:51]
    ds_read2_b32 v[106:107], v19 offset0:146 offset1:147
    v_cvt_pk_bf16_f32 v64, v64, v112
    v_mfma_f32_16x16x32_bf16 v[52:55], v[92:95], v[72:75], v[52:55]
    ds_read_b128 v[76:79], v28 offset:64
    v_cvt_pk_bf16_f32 v65, v65, v113
    v_mfma_f32_16x16x32_bf16 v[56:59], v[84:87], v[72:75], v[56:59]
    ds_read2_b32 v[116:117], v19 offset0:16 offset1:17
    v_cvt_pk_bf16_f32 v66, v66, v114
    v_mfma_f32_16x16x32_bf16 v[60:63], v[96:99], v[72:75], v[60:63]
    ds_read2_b32 v[118:119], v19 offset0:18 offset1:19
    v_cvt_pk_bf16_f32 v67, v67, v115
    s_waitcnt lgkmcnt(5)
    v_mfma_f32_16x16x32_bf16 v[52:55], v[68:71], v[108:111], v[52:55]
    ds_read2_b32 v[120:121], v18 offset0:144 offset1:145
    v_mfma_f32_16x16x32_bf16 v[56:59], v[92:95], v[108:111], v[56:59]
    ds_read2_b32 v[122:123], v18 offset0:146 offset1:147
    v_mfma_f32_16x16x32_bf16 v[60:63], v[84:87], v[108:111], v[60:63]
    ds_read2_b32 v[124:125], v18 offset0:16 offset1:17
    ds_read2_b32 v[126:127], v18 offset0:18 offset1:19
    v_mfma_f32_16x16x32_bf16 v[56:59], v[68:71], v[88:91], v[56:59]
    ds_read_b128 v[96:99], v28 offset:576
    v_mfma_f32_16x16x32_bf16 v[60:63], v[92:95], v[88:91], v[60:63]
    ds_read_b128 v[72:75], v28 offset:1088
    v_mfma_f32_16x16x32_bf16 v[60:63], v[68:71], v[80:83], v[60:63]
    ds_read_b128 v[112:115], v28 offset:1600
    s_waitcnt lgkmcnt(8)
    v_mfma_f32_16x16x32_bf16 v[32:35], v[104:107], v[76:79], v[32:35]
    ds_read_b128 v[84:87], v28 offset:2112
    s_waitcnt lgkmcnt(8)
    v_mfma_f32_16x16x32_bf16 v[36:39], v[116:119], v[76:79], v[36:39]
    ds_read_b128 v[108:111], v28 offset:2624
    s_waitcnt lgkmcnt(7)
    v_mfma_f32_16x16x32_bf16 v[40:43], v[120:123], v[76:79], v[40:43]
    ds_read_b128 v[92:95], v28 offset:3136
    s_waitcnt lgkmcnt(6)
    v_mfma_f32_16x16x32_bf16 v[44:47], v[124:127], v[76:79], v[44:47]
    ds_read_b128 v[88:91], v28 offset:3648
    s_waitcnt lgkmcnt(6)
    v_mfma_f32_16x16x32_bf16 v[36:39], v[104:107], v[96:99], v[36:39]
    ds_read2_b32 v[68:69], v19 offset0:128 offset1:129
    v_mfma_f32_16x16x32_bf16 v[40:43], v[116:119], v[96:99], v[40:43]
    ds_read2_b32 v[70:71], v19 offset0:130 offset1:131
    v_mfma_f32_16x16x32_bf16 v[44:47], v[120:123], v[96:99], v[44:47]
    ds_read_b128 v[80:83], v28 offset:0
    v_mfma_f32_16x16x32_bf16 v[48:51], v[124:127], v[96:99], v[48:51]
    ds_read2_b32 v[76:77], v19 offset0:0 offset1:1
    s_waitcnt lgkmcnt(7)
    v_mfma_f32_16x16x32_bf16 v[40:43], v[104:107], v[72:75], v[40:43]
    ds_read2_b32 v[78:79], v19 offset0:2 offset1:3
    v_mfma_f32_16x16x32_bf16 v[44:47], v[116:119], v[72:75], v[44:47]
    ds_read2_b32 v[96:97], v18 offset0:128 offset1:129
    v_mfma_f32_16x16x32_bf16 v[48:51], v[120:123], v[72:75], v[48:51]
    ds_read2_b32 v[98:99], v18 offset0:130 offset1:131
    v_mfma_f32_16x16x32_bf16 v[52:55], v[124:127], v[72:75], v[52:55]
    ds_read2_b32 v[72:73], v18 offset0:0 offset1:1
    v_mfma_f32_16x16x32_bf16 v[44:47], v[104:107], v[112:115], v[44:47]
    ds_read2_b32 v[74:75], v18 offset0:2 offset1:3
    v_mfma_f32_16x16x32_bf16 v[48:51], v[116:119], v[112:115], v[48:51]
    v_lshl_add_u32 v5, v6, 4, v5
    s_lshl_b32 s64, s3, 10
    v_mfma_f32_16x16x32_bf16 v[52:55], v[120:123], v[112:115], v[52:55]
    v_add_u32 v5, s64, v5
    v_mfma_f32_16x16x32_bf16 v[56:59], v[124:127], v[112:115], v[56:59]
    ds_read2_b32 v[112:113], v27 offset0:0 offset1:1
    v_mfma_f32_16x16x32_bf16 v[48:51], v[104:107], v[84:87], v[48:51]
    ds_read2_b32 v[114:115], v27 offset0:2 offset1:3
    v_mfma_f32_16x16x32_bf16 v[52:55], v[116:119], v[84:87], v[52:55]
    v_lshrrev_b32 v6, 2, v3
    v_mfma_f32_16x16x32_bf16 v[56:59], v[120:123], v[84:87], v[56:59]
    v_mul_u32_u24 v6, 14336, v6
    v_mfma_f32_16x16x32_bf16 v[60:63], v[124:127], v[84:87], v[60:63]
    ds_read2_b32 v[124:125], v15 offset0:3 offset1:2
    s_waitcnt lgkmcnt(3)
    v_mfma_f32_16x16x32_bf16 v[52:55], v[104:107], v[108:111], v[52:55]
    ds_read2_b32 v[126:127], v15 offset0:1 offset1:0
    v_mfma_f32_16x16x32_bf16 v[56:59], v[116:119], v[108:111], v[56:59]
    ds_read_b128 v[84:87], v28 offset:512
    v_mfma_f32_16x16x32_bf16 v[60:63], v[120:123], v[108:111], v[60:63]
    ds_read2_b32 v[120:121], v15 offset0:19 offset1:18
    v_mfma_f32_16x16x32_bf16 v[56:59], v[104:107], v[92:95], v[56:59]
    ds_read2_b32 v[122:123], v15 offset0:17 offset1:16
    v_mfma_f32_16x16x32_bf16 v[60:63], v[116:119], v[92:95], v[60:63]
    ds_read_b128 v[108:111], v28 offset:1024
    v_mfma_f32_16x16x32_bf16 v[60:63], v[104:107], v[88:91], v[60:63]
    ds_read2_b32 v[116:117], v15 offset0:35 offset1:34
    v_mfma_f32_16x16x32_bf16 v[32:35], v[68:71], v[80:83], v[32:35]
    ds_read2_b32 v[118:119], v15 offset0:33 offset1:32
    v_mfma_f32_16x16x32_bf16 v[36:39], v[76:79], v[80:83], v[36:39]
    ds_read_b128 v[92:95], v28 offset:1536
    v_mfma_f32_16x16x32_bf16 v[40:43], v[96:99], v[80:83], v[40:43]
    ds_read2_b32 v[104:105], v15 offset0:51 offset1:50
    v_mfma_f32_16x16x32_bf16 v[44:47], v[72:75], v[80:83], v[44:47]
    ds_read2_b32 v[106:107], v15 offset0:49 offset1:48
    s_waitcnt lgkmcnt(7)
    v_mfma_f32_16x16x32_bf16 v[60:63], v[112:115], v[80:83], v[60:63]
    ds_read_b128 v[88:91], v28 offset:2048
    v_mfma_f32_16x16x32_bf16 v[48:51], v[100:103], v[124:127], v[48:51]
    ds_read_b128 v[112:115], v28 offset:2560
    v_mfma_f32_16x16x32_bf16 v[56:59], v[64:67], v[124:127], v[56:59]
    ds_read_b128 v[80:83], v28 offset:3072
    ds_write_b128 v4, v[32:35] offset:0
    v_mfma_f32_16x16x32_bf16 v[36:39], v[68:71], v[84:87], v[36:39]
    ds_read_b128 v[124:127], v28 offset:3584
    v_mfma_f32_16x16x32_bf16 v[40:43], v[76:79], v[84:87], v[40:43]
    v_and_b32 v7, 3, v3
    v_mfma_f32_16x16x32_bf16 v[44:47], v[96:99], v[84:87], v[44:47]
    v_lshl_add_u32 v6, v7, 4, v6
    s_mul_i32 s64, s3, 229376
    v_mfma_f32_16x16x32_bf16 v[48:51], v[72:75], v[84:87], v[48:51]
    s_lshl_b32 s65, s66, 6
    s_add_u32 s64, s64, s65
    s_waitcnt lgkmcnt(5)
    v_mfma_f32_16x16x32_bf16 v[52:55], v[100:103], v[120:123], v[52:55]
    s_add_u32 s64, s64, 6553600
    v_mfma_f32_16x16x32_bf16 v[60:63], v[64:67], v[120:123], v[60:63]
    v_cmp_eq_u32 s[56:57], 3, v7
    v_mfma_f32_16x16x32_bf16 v[40:43], v[68:71], v[108:111], v[40:43]
    ds_write_b128 v4, v[36:39] offset:1024
    v_mfma_f32_16x16x32_bf16 v[44:47], v[76:79], v[108:111], v[44:47]
    v_mov_b32 v11, s60
    v_mfma_f32_16x16x32_bf16 v[48:51], v[96:99], v[108:111], v[48:51]
    v_and_b32 v9, 7, v1
    v_mfma_f32_16x16x32_bf16 v[52:55], v[72:75], v[108:111], v[52:55]
    v_and_b32 v12, 1, v2
    v_mfma_f32_16x16x32_bf16 v[56:59], v[100:103], v[116:119], v[56:59]
    v_lshl_add_u32 v9, v12, 3, v9
    v_mfma_f32_16x16x32_bf16 v[44:47], v[68:71], v[92:95], v[44:47]
    v_lshrrev_b32 v12, 1, v9
    v_mfma_f32_16x16x32_bf16 v[48:51], v[76:79], v[92:95], v[48:51]
    ds_write_b128 v4, v[40:43] offset:2048
    v_mfma_f32_16x16x32_bf16 v[52:55], v[96:99], v[92:95], v[52:55]
    v_and_b32 v12, 3, v12
    v_mfma_f32_16x16x32_bf16 v[56:59], v[72:75], v[92:95], v[56:59]
    v_xor_b32 v12, 3, v12
    v_mfma_f32_16x16x32_bf16 v[60:63], v[100:103], v[104:107], v[60:63]
    v_lshlrev_b32 v12, 4, v12
    s_waitcnt lgkmcnt(2)
    v_mfma_f32_16x16x32_bf16 v[48:51], v[68:71], v[88:91], v[48:51]
    v_lshl_add_u32 v9, v9, 6, v12
    s_lshl_b32 s72, s3, 10
    v_mfma_f32_16x16x32_bf16 v[52:55], v[76:79], v[88:91], v[52:55]
    ds_write_b128 v4, v[44:47] offset:3072
    v_mfma_f32_16x16x32_bf16 v[56:59], v[96:99], v[88:91], v[56:59]
    s_add_u32 s72, s72, 12
    v_mfma_f32_16x16x32_bf16 v[60:63], v[72:75], v[88:91], v[60:63]
    v_add_u32 v9, s72, v9
    v_mfma_f32_16x16x32_bf16 v[52:55], v[68:71], v[112:115], v[52:55]
    v_mul_u32_u24 v10, 14336, v2
    v_mfma_f32_16x16x32_bf16 v[56:59], v[76:79], v[112:115], v[56:59]
    v_lshl_add_u32 v10, v1, 2, v10
    s_mul_i32 s72, s3, 28672
    v_mfma_f32_16x16x32_bf16 v[60:63], v[96:99], v[112:115], v[60:63]
    ds_write_b128 v4, v[48:51] offset:4096
    v_mfma_f32_16x16x32_bf16 v[56:59], v[68:71], v[80:83], v[56:59]
    s_add_u32 s65, s65, s72
    s_add_u32 s65, s65, 8388608
    v_mfma_f32_16x16x32_bf16 v[60:63], v[76:79], v[80:83], v[60:63]
    v_mfma_f32_16x16x32_bf16 v[60:63], v[68:71], v[124:127], v[60:63]
    ds_write_b128 v4, v[52:55] offset:5120
    s_nop 2
    ds_write_b128 v4, v[56:59] offset:6144
    s_nop 2
    ds_write_b128 v4, v[60:63] offset:7168
L_tC:
    s_setprio 3
    s_waitcnt lgkmcnt(0)
    s_barrier
    ds_read_b128 v[64:67], v5 offset:0
    ds_read_b128 v[72:75], v5 offset:43008
    ds_read_b128 v[80:83], v5 offset:51200
    ds_read_b128 v[88:91], v5 offset:59392
    ds_read_b32 v100, v9 offset:0
    ds_read_b32 v101, v9 offset:43008
    ds_read_b32 v102, v9 offset:51200
    ds_read_b32 v103, v9 offset:59392
    s_waitcnt lgkmcnt(4)
    v_pk_add_f32 v[64:65], v[64:65], v[72:73]
    v_pk_add_f32 v[66:67], v[66:67], v[74:75]
    v_pk_add_f32 v[80:81], v[80:81], v[88:89]
    v_pk_add_f32 v[82:83], v[82:83], v[90:91]
    v_cvt_pk_bf16_f32 v96, v64, v80
    v_cvt_pk_bf16_f32 v97, v65, v81
    v_cvt_pk_bf16_f32 v98, v66, v82
    v_cvt_pk_bf16_f32 v99, v67, v83
    v_cndmask_b32 v99, v99, v11, s[56:57]
    buffer_store_dwordx4 v[96:99], v6, s[32:35], s64 offen sc1
    s_waitcnt lgkmcnt(0)
    v_add_f32 v100, v100, v101
    v_add_f32 v102, v102, v103
    v_cvt_pk_bf16_f32 v100, v100, v102
    v_cndmask_b32 v100, v100, v11, s[62:63]
    s_mov_b32 exec_hi, 0
    buffer_store_dword v100, v10, s[32:35], s65 offen sc1
    s_mov_b64 exec, -1
    s_and_b32 s61, s54, 7
    s_lshl_b32 s61, s61, 10
    s_lshl_b32 s100, s3, 14
    s_add_u32 s61, s61, s100
    s_add_u32 s61, s61, 9699328
    v_lshlrev_b32 v12, 13, v3
    v_mov_b32 v13, 1
    s_mov_b64 exec, 3
    buffer_atomic_add v13, v12, s[32:35], s61 offen sc1
    s_mov_b64 exec, -1
L_exit:
L_end:
    s_endpgm
L_f_z1:
    s_and_b64 s[72:73], s[72:73], s[62:63]
    s_and_b64 s[74:75], s[74:75], s[62:63]
    s_and_b64 s[76:77], s[76:77], s[62:63]
    s_and_b64 s[78:79], s[78:79], s[62:63]
L_q_z1:
    s_add_u32 s70, s70, 1
    s_cmp_gt_u32 s70, 200000
    s_cbranch_scc1 L_exit
    s_mov_b64 exec, s[72:73]
    s_cbranch_execz L_q0_z1
    v_mov_b32 v96, 0
    buffer_atomic_or v96, v27, s[32:35], s69 offen offset:0 sc0 sc1
L_q0_z1:
    s_mov_b64 exec, s[74:75]
    s_cbranch_execz L_q1_z1
    v_mov_b32 v97, 0
    buffer_atomic_or v97, v27, s[32:35], s69 offen offset:64 sc0 sc1
L_q1_z1:
    s_mov_b64 exec, s[76:77]
    s_cbranch_execz L_q2_z1
    v_mov_b32 v98, 0
    buffer_atomic_or v98, v27, s[32:35], s69 offen offset:128 sc0 sc1
L_q2_z1:
    s_mov_b64 exec, s[78:79]
    s_cbranch_execz L_q3_z1
    v_mov_b32 v99, 0
    buffer_atomic_or v99, v27, s[32:35], s69 offen offset:192 sc0 sc1
L_q3_z1:
    s_mov_b64 exec, -1
    s_waitcnt vmcnt(0)
    v_cmp_ne_u32 vcc, s60, v96
    s_nop 0
    s_and_b64 s[72:73], s[72:73], vcc
    v_cmp_ne_u32 vcc, s60, v97
    s_nop 0
    s_and_b64 s[74:75], s[74:75], vcc
    v_cmp_ne_u32 vcc, s60, v98
    s_nop 0
    s_and_b64 s[76:77], s[76:77], vcc
    v_cmp_ne_u32 vcc, s60, v99
    s_nop 0
    s_and_b64 s[78:79], s[78:79], vcc
    s_or_b64 vcc, s[72:73], s[74:75]
    s_or_b64 vcc, vcc, s[76:77]
    s_or_b64 vcc, vcc, s[78:79]
    s_cbranch_scc0 L_r_z1
    s_sleep 2
    s_branch L_q_z1
L_r_z1:
    buffer_load_dword v96, v27, s[32:35], s69 offen offset:0 sc1
    buffer_load_dword v97, v27, s[32:35], s69 offen offset:64 sc1
    buffer_load_dword v98, v27, s[32:35], s69 offen offset:128 sc1
    buffer_load_dword v99, v27, s[32:35], s69 offen offset:192 sc1
    s_waitcnt vmcnt(0)
    s_branch L_chk_z1
L_f_z2:
    s_and_b64 s[72:73], s[72:73], s[62:63]
    s_and_b64 s[74:75], s[74:75], s[62:63]
    s_and_b64 s[76:77], s[76:77], s[62:63]
    s_and_b64 s[78:79], s[78:79], s[62:63]
    s_and_b64 s[48:49], s[48:49], s[62:63]
    s_and_b64 s[50:51], s[50:51], s[62:63]
    s_and_b64 s[52:53], s[52:53], s[62:63]
    s_and_b64 s[40:41], s[40:41], s[62:63]
L_q_z2:
    s_add_u32 s70, s70, 1
    s_cmp_gt_u32 s70, 200000
    s_cbranch_scc1 L_exit
    s_mov_b64 exec, s[72:73]
    s_cbranch_execz L_q0_z2
    v_mov_b32 v96, 0
    buffer_atomic_or v96, v5, s[32:35], s69 offen offset:0 sc0 sc1
L_q0_z2:
    s_mov_b64 exec, s[74:75]
    s_cbranch_execz L_q1_z2
    v_mov_b32 v97, 0
    buffer_atomic_or v97, v5, s[32:35], s69 offen offset:64 sc0 sc1
L_q1_z2:
    s_mov_b64 exec, s[76:77]
    s_cbranch_execz L_q2_z2
    v_mov_b32 v98, 0
    buffer_atomic_or v98, v5, s[32:35], s69 offen offset:128 sc0 sc1
L_q2_z2:
    s_mov_b64 exec, s[78:79]
    s_cbranch_execz L_q3_z2
    v_mov_b32 v99, 0
    buffer_atomic_or v99, v5, s[32:35], s69 offen offset:192 sc0 sc1
L_q3_z2:
    s_mov_b64 exec, s[48:49]
    s_cbranch_execz L_q4_z2
    v_mov_b32 v100, 0
    buffer_atomic_or v100, v5, s[32:35], s69 offen offset:1024 sc0 sc1
L_q4_z2:
    s_mov_b64 exec, s[50:51]
    s_cbranch_execz L_q5_z2
    v_mov_b32 v101, 0
    buffer_atomic_or v101, v5, s[32:35], s69 offen offset:1088 sc0 sc1
L_q5_z2:
    s_mov_b64 exec, s[52:53]
    s_cbranch_execz L_q6_z2
    v_mov_b32 v102, 0
    buffer_atomic_or v102, v5, s[32:35], s69 offen offset:1152 sc0 sc1
L_q6_z2:
    s_mov_b64 exec, s[40:41]
    s_cbranch_execz L_q7_z2
    v_mov_b32 v103, 0
    buffer_atomic_or v103, v5, s[32:35], s69 offen offset:1216 sc0 sc1
L_q7_z2:
    s_mov_b64 exec, -1
    s_waitcnt vmcnt(0)
    v_cmp_ne_u32 vcc, s60, v96
    s_nop 0
    s_and_b64 s[72:73], s[72:73], vcc
    v_cmp_ne_u32 vcc, s60, v97
    s_nop 0
    s_and_b64 s[74:75], s[74:75], vcc
    v_cmp_ne_u32 vcc, s60, v98
    s_nop 0
    s_and_b64 s[76:77], s[76:77], vcc
    v_cmp_ne_u32 vcc, s60, v99
    s_nop 0
    s_and_b64 s[78:79], s[78:79], vcc
    v_cmp_ne_u32 vcc, s60, v100
    s_nop 0
    s_and_b64 s[48:49], s[48:49], vcc
    v_cmp_ne_u32 vcc, s60, v101
    s_nop 0
    s_and_b64 s[50:51], s[50:51], vcc
    v_cmp_ne_u32 vcc, s60, v102
    s_nop 0
    s_and_b64 s[52:53], s[52:53], vcc
    v_cmp_ne_u32 vcc, s60, v103
    s_nop 0
    s_and_b64 s[40:41], s[40:41], vcc
    s_or_b64 vcc, s[72:73], s[74:75]
    s_or_b64 vcc, vcc, s[76:77]
    s_or_b64 vcc, vcc, s[78:79]
    s_or_b64 vcc, vcc, s[48:49]
    s_or_b64 vcc, vcc, s[50:51]
    s_or_b64 vcc, vcc, s[52:53]
    s_or_b64 vcc, vcc, s[40:41]
    s_cbranch_scc0 L_r_z2
    s_sleep 2
    s_branch L_q_z2
L_r_z2:
    buffer_load_dword v96, v5, s[32:35], s69 offen offset:0 sc1
    buffer_load_dword v97, v5, s[32:35], s69 offen offset:64 sc1
    buffer_load_dword v98, v5, s[32:35], s69 offen offset:128 sc1
    buffer_load_dword v99, v5, s[32:35], s69 offen offset:192 sc1
    buffer_load_dword v100, v5, s[32:35], s69 offen offset:1024 sc1
    buffer_load_dword v101, v5, s[32:35], s69 offen offset:1088 sc1
    buffer_load_dword v102, v5, s[32:35], s69 offen offset:1152 sc1
    buffer_load_dword v103, v5, s[32:35], s69 offen offset:1216 sc1
    s_waitcnt vmcnt(0)
    s_branch L_chk_z2
L_f_y:
    s_and_b64 s[72:73], s[72:73], s[56:57]
    s_and_b64 s[74:75], s[74:75], s[56:57]
L_q_y:
    s_add_u32 s70, s70, 1
    s_cmp_gt_u32 s70, 200000
    s_cbranch_scc1 L_exit
    s_mov_b64 exec, s[72:73]
    s_cbranch_execz L_q0_y
    v_mov_b32 v99, 0
    buffer_atomic_or v99, v7, s[32:35], s29 offen offset:12 sc0 sc1
L_q0_y:
    s_mov_b64 exec, s[74:75]
    s_cbranch_execz L_q1_y
    v_mov_b32 v103, 0
    buffer_atomic_or v103, v7, s[32:35], s29 offen offset:1036 sc0 sc1
L_q1_y:
    s_mov_b64 exec, -1
    s_waitcnt vmcnt(0)
    v_cmp_ne_u32 vcc, s60, v99
    s_nop 0
    s_and_b64 s[72:73], s[72:73], vcc
    v_cmp_ne_u32 vcc, s60, v103
    s_nop 0
    s_and_b64 s[74:75], s[74:75], vcc
    s_or_b64 vcc, s[72:73], s[74:75]
    s_cbranch_scc0 L_r_y
    s_sleep 2
    s_branch L_q_y
L_r_y:
    buffer_load_dwordx4 v[96:99], v7, s[32:35], s29 offen sc1
    s_mov_b64 exec, s[30:31]
    buffer_load_dwordx4 v[100:103], v7, s[32:35], s29 offen offset:1024 sc1
    s_mov_b64 exec, -1
    s_waitcnt vmcnt(0)
    s_branch L_chk_y
L_f_u:
L_q_u:
    s_add_u32 s70, s70, 1
    s_cmp_gt_u32 s70, 200000
    s_cbranch_scc1 L_exit
    s_mov_b64 exec, s[72:73]
    s_cbranch_execz L_q0_u
    v_mov_b32 v119, 0
    buffer_atomic_or v119, v25, s[32:35], s57 offen offset:12 sc0 sc1
L_q0_u:
    s_mov_b64 exec, s[74:75]
    s_cbranch_execz L_q1_u
    v_mov_b32 v120, 0
    buffer_atomic_or v120, v29, s[32:35], s55 offen offset:0 sc0 sc1
L_q1_u:
    s_mov_b64 exec, -1
    s_waitcnt vmcnt(0)
    v_cmp_ne_u32 vcc, s60, v119
    s_nop 0
    s_and_b64 s[72:73], s[72:73], vcc
    v_cmp_ne_u32 vcc, s60, v120
    s_nop 0
    s_and_b64 s[74:75], s[74:75], vcc
    s_or_b64 vcc, s[72:73], s[74:75]
    s_cbranch_scc0 L_r_u
    s_sleep 16
    s_branch L_q_u
L_r_u:
    buffer_load_dwordx4 v[116:119], v25, s[32:35], s57 offen sc1
    s_mov_b32 exec_hi, 0
    buffer_load_dword v120, v29, s[32:35], s55 offen sc1
    s_mov_b64 exec, -1
    s_waitcnt vmcnt(0)
    s_branch L_chk_u
.p2align 8
.type L_tbl,@object
L_tbl:
.long 0x3f803f80,0x3f803f80,0x3f803f80,0x3f803f80,0x3f7a3f80,0x3f483f67,0xbf48bf67,0xbedebf20
.long 0x3f673f80,0x3e643f20,0x3e643f20,0xbf20be64,0x3f483f80,0xbede3e64,0x3edebe64,0x3f7a3f67
.long 0x3f203f80,0xbf67be64,0xbf67be64,0xbe64bf67,0x3ede3f80,0xbf7abf20,0x3f7a3f20,0xbf483e64
.long 0x3e643f80,0xbf20bf67,0xbf20bf67,0x3f673f20,0x3f80,0xbf80,0x3f80,0xbf80
.long 0xbe643f80,0x3f20bf67,0x3f20bf67,0xbf673f20,0xbede3f80,0x3f7abf20,0xbf7a3f20,0x3f483e64
.long 0xbf203f80,0x3f67be64,0x3f67be64,0x3e64bf67,0xbf483f80,0x3ede3e64,0xbedebe64,0xbf7a3f67
.long 0xbf673f80,0xbe643f20,0xbe643f20,0x3f20be64,0xbf7a3f80,0xbf483f67,0x3f48bf67,0x3edebf20
.long 0xbf803f80,0xbf803f80,0xbf803f80,0xbf803f80,0xbf7a3f80,0xbf483f67,0x3f48bf67,0x3edebf20
.long 0x3f803f80,0x3f803f80,0x3f803f80,0x3f803f80,0x3ede3f20,0x3e64,0xbe64,0x3ede3e64
.long 0xbf20be64,0xbf80bf67,0xbf80bf67,0xbf20bf67,0xbf7abf67,0xbf20,0x3f20,0xbf7abf20
.long 0xbe64bf67,0x3f803f20,0x3f803f20,0xbe643f20,0x3f48be64,0x3f67,0xbf67,0x3f483f67
.long 0x3f673f20,0xbf80be64,0xbf80be64,0x3f67be64,0x3f80,0xbf80,0x3f80,0xbf80
.long 0xbf673f20,0x3f80be64,0x3f80be64,0xbf67be64,0xbf48be64,0x3f67,0xbf67,0xbf483f67
.long 0x3e64bf67,0xbf803f20,0xbf803f20,0x3e643f20,0x3f7abf67,0xbf20,0x3f20,0x3f7abf20
.long 0x3f20be64,0x3f80bf67,0x3f80bf67,0x3f20bf67,0xbede3f20,0x3e64,0xbe64,0xbede3e64
.long 0xbf803f80,0xbf803f80,0xbf803f80,0xbf803f80,0xbede3f20,0x3e64,0xbe64,0xbede3e64
.long 0x3f803f80,0x3f803f80,0x3f803f80,0x3f803f80,0xbedebe64,0xbf48bf20,0x3f483f20,0x3f7a3f67
.long 0xbf20bf67,0x3e64be64,0x3e64be64,0x3f673f20,0x3f7a3f20,0x3ede3f67,0xbedebf67,0x3f483e64
.long 0xbe643f20,0xbf67bf67,0xbf67bf67,0x3f20be64,0xbf48bf67,0x3f7a3e64,0xbf7abe64,0x3edebf20
.long 0x3f67be64,0xbf203f20,0xbf203f20,0x3e64bf67,0x3f80,0xbf80,0x3f80,0xbf80
.long 0xbf67be64,0x3f203f20,0x3f203f20,0xbe64bf67,0x3f48bf67,0xbf7a3e64,0x3f7abe64,0xbedebf20
.long 0x3e643f20,0x3f67bf67,0x3f67bf67,0xbf20be64,0xbf7a3f20,0xbede3f67,0x3edebf67,0xbf483e64
.long 0x3f20bf67,0xbe64be64,0xbe64be64,0xbf673f20,0x3edebe64,0x3f48bf20,0xbf483f20,0xbf7a3f67
.long 0xbf803f80,0xbf803f80,0xbf803f80,0xbf803f80,0x3edebe64,0x3f48bf20,0xbf483f20,0xbf7a3f67
.long 0x3f803f80,0x3f803f80,0,0,0xbf7abf67,0xbf7abf80,0,0
.long 0x3f673f20,0x3f673f80,0,0,0xbf48be64,0xbf48bf80,0,0x80000000
.long 0x3f20be64,0x3f203f80,0,0x80008000,0xbede3f20,0xbedebf80,0,0x80008000
.long 0x3e64bf67,0x3e643f80,0,0x80008000,0x3f80,0xbf80,0,0x8000
.long 0xbe64bf67,0xbe643f80,0x80000000,0x8000,0x3ede3f20,0x3edebf80,0x80000000,0x8000
.long 0xbf20be64,0xbf203f80,0x80000000,0x8000,0x3f48be64,0x3f48bf80,0x80000000,0
.long 0xbf673f20,0xbf673f80,0x80000000,0x80000000,0x3f7abf67,0x3f7abf80,0x80000000,0x80000000
.long 0xbf803f80,0xbf803f80,0x80000000,0x80000000,0x3f7abf67,0x3f7abf80,0x80000000,0x80000000
.long 0x80008000,0x80008000,0x80008000,0x80008000,0xbe648000,0xbf20bede,0x3f203ede,0x3f673f48
.long 0xbede8000,0xbf7abf48,0xbf7abf48,0xbf48bf7a,0xbf208000,0xbf67bf7a,0x3f673f7a,0xbe643ede
.long 0xbf488000,0xbedebf7a,0xbedebf7a,0x3f7a3ede,0xbf678000,0x3e64bf48,0xbe643f48,0xbf20bf7a
.long 0xbf7a8000,0x3f48bede,0x3f48bede,0xbede3f48,0xbf808000,0x3f808000,0xbf808000,0x3f808000
.long 0xbf7a8000,0x3f483ede,0x3f483ede,0xbedebf48,0xbf678000,0x3e643f48,0xbe64bf48,0xbf203f7a
.long 0xbf488000,0xbede3f7a,0xbede3f7a,0x3f7abede,0xbf208000,0xbf673f7a,0x3f67bf7a,0xbe64bede
.long 0xbede8000,0xbf7a3f48,0xbf7a3f48,0xbf483f7a,0xbe648000,0xbf203ede,0x3f20bede,0x3f67bf48
.long 0x80008000,0x80008000,0x80008000,0x80008000,0x3e648000,0x3f20bede,0xbf203ede,0xbf673f48
.long 0x80008000,0x80008000,0x80008000,0x80008000,0xbf67bf48,0xbf80bf7a,0x3f803f7a,0x3f673f7a
.long 0xbf48bf7a,0x8000bede,0x8000bede,0x3f483ede,0x3e64bede,0x3f803f48,0xbf80bf48,0xbe64bf48
.long 0x3f7a3ede,0x80003f48,0x80003f48,0xbf7abf48,0x3f203f7a,0xbf80bede,0x3f803ede,0xbf203ede
.long 0xbede3f48,0x8000bf7a,0x8000bf7a,0x3ede3f7a,0xbf808000,0x3f808000,0xbf808000,0x3f808000
.long 0xbedebf48,0x80003f7a,0x80003f7a,0x3edebf7a,0x3f20bf7a,0xbf803ede,0x3f80bede,0xbf20bede
.long 0x3f7abede,0x8000bf48,0x8000bf48,0xbf7a3f48,0x3e643ede,0x3f80bf48,0xbf803f48,0xbe643f48
.long 0xbf483f7a,0x80003ede,0x80003ede,0x3f48bede,0xbf673f48,0xbf803f7a,0x3f80bf7a,0x3f67bf7a
.long 0x80008000,0x80008000,0x80008000,0x80008000,0x3f67bf48,0x3f80bf7a,0xbf803f7a,0xbf673f7a
.long 0x80008000,0x80008000,0x80008000,0x80008000,0xbf67bf7a,0xbf20bf48,0x3f203f48,0x3e643ede
.long 0x3f483ede,0x3f7a3f7a,0x3f7a3f7a,0x3ede3f48,0x3e643f48,0xbf67bede,0x3f673ede,0x3f203f7a
.long 0xbf7abf48,0x3edebede,0x3edebede,0x3f483f7a,0x3f20bede,0x3e643f7a,0xbe64bf7a,0x3f673f48
.long 0x3ede3f7a,0xbf48bf48,0xbf48bf48,0x3f7a3ede,0xbf808000,0x3f808000,0xbf808000,0x3f808000
.long 0x3edebf7a,0xbf483f48,0xbf483f48,0x3f7abede,0x3f203ede,0x3e64bf7a,0xbe643f7a,0x3f67bf48
.long 0xbf7a3f48,0x3ede3ede,0x3ede3ede,0x3f48bf7a,0x3e64bf48,0xbf673ede,0x3f67bede,0x3f20bf7a
.long 0x3f48bede,0x3f7abf7a,0x3f7abf7a,0x3edebf48,0xbf673f7a,0xbf203f48,0x3f20bf48,0x3e64bede
.long 0x80008000,0x80008000,0x80008000,0x80008000,0x3f67bf7a,0x3f20bf48,0xbf203f48,0xbe643ede
.long 0x80008000,0x80008000,0x80008000,0x80008000,0xbe64bede,0x3e648000,0x80008000,0x80008000
.long 0x3ede3f48,0xbede8000,0x80008000,0x80008000,0xbf20bf7a,0x3f208000,0x80008000,0x80008000
.long 0x3f483f7a,0xbf488000,0x80008000,0x80008000,0xbf67bf48,0x3f678000,0x80008000,0x8000
.long 0x3f7a3ede,0xbf7a8000,0x80008000,0x8000,0xbf808000,0x3f808000,0x80008000,0x8000
.long 0x3f7abede,0xbf7a8000,0x80008000,0,0xbf673f48,0x3f678000,0x80008000,0
.long 0x3f48bf7a,0xbf488000,0x80008000,0x80000000,0xbf203f7a,0x3f208000,0x80008000,0x80000000
.long 0x3edebf48,0xbede8000,0x80008000,0x80000000,0xbe643ede,0x3e648000,0x80008000,0x80000000
.long 0x80008000,0x80008000,0x80008000,0x80008000,0x3e64bede,0xbe648000,0x8000,0x8000
.long 0x3f80,0x3f80,0x3f80,0x3f80,0x3f80,0x3ec43f6d,0x3f353f35,0x3f6d3ec4
.long 0x3f80,0x3f353f35,0x3f800000,0x3f35bf35,0x3f80,0x3f6d3ec4,0x3f35bf35,0xbec4bf6d
.long 0x3f80,0x3f800000,0xbf80,0xbf800000,0x3f80,0x3f6dbec4,0xbf35bf35,0xbec43f6d
.long 0x3f80,0x3f35bf35,0xbf800000,0x3f353f35,0x3f80,0x3ec4bf6d,0xbf353f35,0x3f6dbec4
.long 0x3f80,0xbf80,0x3f80,0xbf80,0x3f80,0xbec4bf6d,0x3f353f35,0xbf6dbec4
.long 0x3f80,0xbf35bf35,0x3f800000,0xbf353f35,0x3f80,0xbf6dbec4,0x3f35bf35,0x3ec43f6d
.long 0x3f80,0xbf800000,0xbf80,0x3f800000,0x3f80,0xbf6d3ec4,0xbf35bf35,0x3ec4bf6d
.long 0x3f80,0xbf353f35,0xbf800000,0xbf35bf35,0x3f80,0xbec43f6d,0xbf353f35,0xbf6d3ec4
.long 0x3f80,0x3f80,0x3f80,0x3f80,0x3f800000,0x3f6dbec4,0x3f35bf35,0x3ec4bf6d
.long 0xbf80,0xbf35bf35,0xbf800000,0xbf353f35,0xbf800000,0xbec43f6d,0x3f353f35,0x3f6dbec4
.long 0x3f80,0x3f800000,0xbf80,0xbf800000,0x3f800000,0xbec4bf6d,0xbf353f35,0x3f6d3ec4
.long 0xbf80,0xbf353f35,0x3f800000,0xbf35bf35,0xbf800000,0x3f6d3ec4,0xbf35bf35,0x3ec43f6d
.long 0x3f80,0xbf80,0x3f80,0xbf80,0x3f800000,0xbf6d3ec4,0x3f35bf35,0xbec43f6d
.long 0xbf80,0x3f353f35,0xbf800000,0x3f35bf35,0xbf800000,0x3ec4bf6d,0x3f353f35,0xbf6d3ec4
.long 0x3f80,0xbf800000,0xbf80,0x3f800000,0x3f800000,0x3ec43f6d,0xbf353f35,0xbf6dbec4
.long 0xbf80,0x3f35bf35,0x3f800000,0x3f353f35,0xbf800000,0xbf6dbec4,0xbf35bf35,0xbec4bf6d
.long 0x3f80,0x3f80,0x3f80,0x3f80,0xbf80,0xbec4bf6d,0xbf35bf35,0xbf6dbec4
.long 0x3f80,0x3f353f35,0x3f800000,0x3f35bf35,0xbf80,0xbf6dbec4,0xbf353f35,0x3ec43f6d
.long 0x3f80,0x3f800000,0xbf80,0xbf800000,0xbf80,0xbf6d3ec4,0x3f353f35,0x3ec4bf6d
.long 0x3f80,0x3f35bf35,0xbf800000,0x3f353f35,0xbf80,0xbec43f6d,0x3f35bf35,0xbf6d3ec4
.long 0x3f80,0xbf80,0x3f80,0xbf80,0xbf80,0x3ec43f6d,0xbf35bf35,0x3f6d3ec4
.long 0x3f80,0xbf35bf35,0x3f800000,0xbf353f35,0xbf80,0x3f6d3ec4,0xbf353f35,0xbec4bf6d
.long 0x3f80,0xbf800000,0xbf80,0x3f800000,0xbf80,0x3f6dbec4,0x3f353f35,0xbec43f6d
.long 0x3f80,0xbf353f35,0xbf800000,0xbf35bf35,0xbf80,0x3ec4bf6d,0x3f35bf35,0x3f6dbec4
.long 0x3f80,0x3f80,0x3f80,0x3f80,0xbf800000,0xbf6d3ec4,0xbf353f35,0xbec43f6d
.long 0xbf80,0xbf35bf35,0xbf800000,0xbf353f35,0x3f800000,0x3ec4bf6d,0xbf35bf35,0xbf6d3ec4
.long 0x3f80,0x3f800000,0xbf80,0xbf800000,0xbf800000,0x3ec43f6d,0x3f35bf35,0xbf6dbec4
.long 0xbf80,0xbf353f35,0x3f800000,0xbf35bf35,0x3f800000,0xbf6dbec4,0x3f353f35,0xbec4bf6d
.long 0x3f80,0xbf80,0x3f80,0xbf80,0xbf800000,0x3f6dbec4,0xbf353f35,0x3ec4bf6d
.long 0xbf80,0x3f353f35,0xbf800000,0x3f35bf35,0x3f800000,0xbec43f6d,0xbf35bf35,0x3f6dbec4
.long 0x3f80,0xbf800000,0xbf80,0x3f800000,0xbf800000,0xbec4bf6d,0x3f35bf35,0x3f6d3ec4
.long 0xbf80,0x3f35bf35,0x3f800000,0x3f353f35,0x3f800000,0x3f6d3ec4,0x3f353f35,0x3ec43f6d
.long 0x3f808000,0x3f808000,0x3f808000,0x3f808000,0x3f808000,0x3f6dbec4,0x3f35bf35,0x3ec4bf6d
.long 0x3f808000,0x3f35bf35,0xbf80,0xbf35bf35,0x3f808000,0x3ec4bf6d,0xbf35bf35,0xbf6d3ec4
.long 0x3f808000,0xbf80,0xbf808000,0x3f80,0x3f808000,0xbec4bf6d,0xbf353f35,0x3f6d3ec4
.long 0x3f808000,0xbf35bf35,0x3f80,0x3f35bf35,0x3f808000,0xbf6dbec4,0x3f353f35,0xbec4bf6d
.long 0xbf800000,0x3f800000,0xbf800000,0x3f800000,0xbf800000,0x3f6dbec4,0xbf353f35,0x3ec4bf6d
.long 0xbf800000,0x3f35bf35,0x80003f80,0xbf35bf35,0xbf800000,0x3ec4bf6d,0x3f353f35,0xbf6d3ec4
.long 0xbf800000,0x8000bf80,0x3f800000,0x80003f80,0xbf800000,0xbec4bf6d,0x3f35bf35,0x3f6d3ec4
.long 0xbf800000,0xbf35bf35,0x8000bf80,0x3f35bf35,0xbf800000,0xbf6dbec4,0xbf35bf35,0xbec4bf6d
.long 0x3f808000,0x3f808000,0x3f808000,0x3f808000,0xbf80,0xbec4bf6d,0xbf35bf35,0xbf6dbec4
.long 0xbf808000,0xbf353f35,0x3f80,0x3f353f35,0x3f80,0x3f6d3ec4,0x3f35bf35,0xbec4bf6d
.long 0x3f808000,0xbf80,0xbf808000,0x3f80,0xbf80,0xbf6d3ec4,0x3f353f35,0x3ec4bf6d
.long 0xbf808000,0x3f353f35,0xbf80,0xbf353f35,0x3f80,0x3ec4bf6d,0xbf353f35,0x3f6dbec4
.long 0xbf800000,0x3f800000,0xbf800000,0x3f800000,0x80003f80,0xbec4bf6d,0x3f353f35,0xbf6dbec4
.long 0x3f800000,0xbf353f35,0x8000bf80,0x3f353f35,0x8000bf80,0x3f6d3ec4,0xbf353f35,0xbec4bf6d
.long 0xbf800000,0x8000bf80,0x3f800000,0x80003f80,0x80003f80,0xbf6d3ec4,0xbf35bf35,0x3ec4bf6d
.long 0x3f800000,0x3f353f35,0x80003f80,0xbf353f35,0x8000bf80,0x3ec4bf6d,0x3f35bf35,0x3f6dbec4
.long 0x3f808000,0x3f808000,0x3f808000,0x3f808000,0xbf808000,0xbf6d3ec4,0xbf353f35,0xbec43f6d
.long 0x3f808000,0x3f35bf35,0xbf80,0xbf35bf35,0xbf808000,0xbec43f6d,0x3f353f35,0x3f6dbec4
.long 0x3f808000,0xbf80,0xbf808000,0x3f80,0xbf808000,0x3ec43f6d,0x3f35bf35,0xbf6dbec4
.long 0x3f808000,0xbf35bf35,0x3f80,0x3f35bf35,0xbf808000,0x3f6d3ec4,0xbf35bf35,0x3ec43f6d
.long 0xbf800000,0x3f800000,0xbf800000,0x3f800000,0x3f800000,0xbf6d3ec4,0x3f35bf35,0xbec43f6d
.long 0xbf800000,0x3f35bf35,0x80003f80,0xbf35bf35,0x3f800000,0xbec43f6d,0xbf35bf35,0x3f6dbec4
.long 0xbf800000,0x8000bf80,0x3f800000,0x80003f80,0x3f800000,0x3ec43f6d,0xbf353f35,0xbf6dbec4
.long 0xbf800000,0xbf35bf35,0x8000bf80,0x3f35bf35,0x3f800000,0x3f6d3ec4,0x3f353f35,0x3ec43f6d
.long 0x3f808000,0x3f808000,0x3f808000,0x3f808000,0x3f80,0x3ec43f6d,0x3f353f35,0x3f6d3ec4
.long 0xbf808000,0xbf353f35,0x3f80,0x3f353f35,0xbf80,0xbf6dbec4,0xbf353f35,0x3ec43f6d
.long 0x3f808000,0xbf80,0xbf808000,0x3f80,0x3f80,0x3f6dbec4,0xbf35bf35,0xbec43f6d
.long 0xbf808000,0x3f353f35,0xbf80,0xbf353f35,0xbf80,0xbec43f6d,0x3f35bf35,0xbf6d3ec4
.long 0xbf800000,0x3f800000,0xbf800000,0x3f800000,0x8000bf80,0x3ec43f6d,0xbf35bf35,0x3f6d3ec4
.long 0x3f800000,0xbf353f35,0x8000bf80,0x3f353f35,0x80003f80,0xbf6dbec4,0x3f35bf35,0x3ec43f6d
.long 0xbf800000,0x8000bf80,0x3f800000,0x80003f80,0x8000bf80,0x3f6dbec4,0x3f353f35,0xbec43f6d
.long 0x3f800000,0x3f353f35,0x80003f80,0xbf353f35,0x80003f80,0xbec43f6d,0xbf353f35,0xbf6d3ec4
.long 0x3f800000,0x3f800000,0x3f800000,0x3f800000,0x3f800000,0x3f7ff98e,0x3f7fe638,0x3f7fc600
.long 0x3f800000,0x3f7fe638,0x3f7f98e6,0x3f7f181a,0x3f800000,0x3f7fc600,0x3f7f181a,0x3f7df69c
.long 0x3f800000,0x3f7f98e6,0x3f7e63ec,0x3f7c620b,0x3f800000,0x3f7f5eee,0x3f7d7c83,0x3f7a5b1d
.long 0x3f800000,0x3f7f181a,0x3f7c620b,0x3f77e2bd,0x3f800000,0x3f7ec46d,0x3f7b14be,0x3f74fa0b
.long 0x3f800000,0x3f7e63ec,0x3f7994e0,0x3f71a257,0x3f800000,0x3f7df69c,0x3f77e2bd,0x3f6ddd24
.long 0x3f800000,0x3f7d7c83,0x3f75fead,0x3f69ac2a,0x3f800000,0x3f7cf5a5,0x3f73e912,0x3f65114d
.long 0x3f800000,0x3f7c620b,0x3f71a257,0x3f600ea4,0x3f800000,0x3f7bc1bb,0x3f6f2af0,0x3f5aa675
.long 0x3f800000,0x3f7b14be,0x3f6c835e,0x3f54db31,0x3f800000,0x3f7a5b1d,0x3f69ac2a,0x3f4eaf7a
.long 0x3f800000,0x3f800000,0x3f800000,0x3f800000,0x3f7f98e6,0x3f7f5eee,0x3f7f181a,0x3f7ec46d
.long 0x3f7e63ec,0x3f7d7c83,0x3f7c620b,0x3f7b14be,0x3f7c620b,0x3f7a5b1d,0x3f77e2bd,0x3f74fa0b
.long 0x3f7994e0,0x3f75fead,0x3f71a257,0x3f6c835e,0x3f75fead,0x3f706cb1,0x3f69ac2a,0x3f61c598
.long 0x3f71a257,0x3f69ac2a,0x3f600ea4,0x3f54db31,0x3f6c835e,0x3f61c598,0x3f54db31,0x3f45e403
.long 0x3f66a5e5,0x3f58c2eb,0x3f48261c,0x3f3504f3,0x3f600ea4,0x3f4eaf7a,0x3f3a0669,0x3f226799
.long 0x3f58c2eb,0x3f4397f4,0x3f2a95b0,0x3f0e39da,0x3f50c899,0x3f378a4d,0x3f19efeb,0x3ef15aea
.long 0x3f48261c,0x3f2a95b0,0x3f083341,0x3ec3ef15,0x3f3ee268,0x3f1cca6b,0x3eeaffac,0x3e94a031
.long 0x3f3504f3,0x3f0e39da,0x3ec3ef15,0x3e47c5c2,0x3f2a95b0,0x3efdec9f,0x3e9b7b85,0x3dc8bd36
.long 0x3f800000,0x3f800000,0x3f800000,0x3f800000,0x3f7e63ec,0x3f7df69c,0x3f7d7c83,0x3f7cf5a5
.long 0x3f7994e0,0x3f77e2bd,0x3f75fead,0x3f73e912,0x3f71a257,0x3f6ddd24,0x3f69ac2a,0x3f65114d
.long 0x3f66a5e5,0x3f600ea4,0x3f58c2eb,0x3f50c899,0x3f58c2eb,0x3f4eaf7a,0x3f4397f4,0x3f378a4d
.long 0x3f48261c,0x3f3a0669,0x3f2a95b0,0x3f19efeb,0x3f3504f3,0x3f226799,0x3f0e39da,0x3ef15aea
.long 0x3f1f9d07,0x3f083341,0x3ede2602,0x3ea91a56,0x3f083341,0x3ed7a83d,0x3e9b7b85,0x3e39aaee
.long 0x3ede2602,0x3e9b7b85,0x3e2b86c0,0x3ce5c143,0x3ea91a56,0x3e39aaee,0x3ce5c143,0xbe00e941
.long 0x3e63dc87,0x3d65aa20,0xbde54da2,0xbe8dbd62,0x3de54da2,0xbd8f7f7c,0xbe7fc568,0xbed7a83d
.long 0,0xbe47c5c2,0xbec3ef15,0xbf0e39da,0xbde54da2,0xbea24f04,0xbf02113a,0xbf2d3eb9
.long 0x3f800000,0x3f800000,0x3f800000,0x3f800000,0x3f7c620b,0x3f7bc1bb,0x3f7b14be,0x3f7a5b1d
.long 0x3f71a257,0x3f6f2af0,0x3f6c835e,0x3f69ac2a,0x3f600ea4,0x3f5aa675,0x3f54db31,0x3f4eaf7a
.long 0x3f48261c,0x3f3ee268,0x3f3504f3,0x3f2a95b0,0x3f2a95b0,0x3f1cca6b,0x3f0e39da,0x3efdec9f
.long 0x3f083341,0x3eeaffac,0x3ec3ef15,0x3e9b7b85,0x3ec3ef15,0x3e94a031,0x3e47c5c2,0x3dc8bd36
.long 0x3e63dc87,0x3de54da2,0,0xbde54da2,0x3d65aa20,0xbd8f7f7c,0xbe47c5c2,0xbea24f04
.long 0xbde54da2,0xbe7fc568,0xbec3ef15,0xbf02113a,0xbe8dbd62,0xbed7a83d,0xbf0e39da,0xbf2d3eb9
.long 0xbede2602,0xbf1423cd,0xbf3504f3,0xbf50c899,0xbf1423cd,0xbf378a4d,0xbf54db31,0xbf6b1db0
.long 0xbf3504f3,0xbf54db31,0xbf6c835e,0xbf7b14be,0xbf50c899,0xbf6b1db0,0xbf7b14be,0xbf7ff98e
.long 0,0,0,0,0,0x3c65c70c,0x3ce5c143,0x3d2c49b7
.long 0,0x3ce5c143,0x3d65aa20,0x3dac22ae,0,0x3d2c49b7,0x3dac22ae,0x3e00e941
.long 0,0x3d65aa20,0x3de54da2,0x3e2b86c0,0,0x3d8f7f7c,0x3e0f2533,0x3e55d687
.long 0,0x3dac22ae,0x3e2b86c0,0x3e7fc568,0,0x3dc8bd36,0x3e47c5c2,0x3e94a031
.long 0,0x3de54da2,0x3e63dc87,0x3ea91a56,0,0x3e00e941,0x3e7fc568,0x3ebd47db
.long 0,0x3e0f2533,0x3e8dbd62,0x3ed11f9b,0,0x3e1d59f0,0x3e9b7b85,0x3ee49898
.long 0,0x3e2b86c0,0x3ea91a56,0x3ef7aa01,0,0x3e39aaee,0x3eb69719,0x3f052598
.long 0,0x3e47c5c2,0x3ec3ef15,0x3f0e39da,0,0x3e55d687,0x3ed11f9b,0x3f170daa
.long 0,0,0,0,0x3d65aa20,0x3d8f7f7c,0x3dac22ae,0x3dc8bd36
.long 0x3de54da2,0x3e0f2533,0x3e2b86c0,0x3e47c5c2,0x3e2b86c0,0x3e55d687,0x3e7fc568,0x3e94a031
.long 0x3e63dc87,0x3e8dbd62,0x3ea91a56,0x3ec3ef15,0x3e8dbd62,0x3eafdd25,0x3ed11f9b,0x3ef15aea
.long 0x3ea91a56,0x3ed11f9b,0x3ef7aa01,0x3f0e39da,0x3ec3ef15,0x3ef15aea,0x3f0e39da,0x3f226799
.long 0x3ede2602,0x3f083341,0x3f1f9d07,0x3f3504f3,0x3ef7aa01,0x3f170daa,0x3f2fdf08,0x3f45e403
.long 0x3f083341,0x3f2529fe,0x3f3ee268,0x3f54db31,0x3f1423cd,0x3f32767c,0x3f4c8bf3,0x3f61c598
.long 0x3f1f9d07,0x3f3ee268,0x3f58c2eb,0x3f6c835e,0x3f2a95b0,0x3f4a5e20,0x3f63712c,0x3f74fa0b
.long 0x3f3504f3,0x3f54db31,0x3f6c835e,0x3f7b14be,0x3f3ee268,0x3f5e4c69,0x3f73e912,0x3f7ec46d
.long 0,0,0,0,0x3de54da2,0x3e00e941,0x3e0f2533,0x3e1d59f0
.long 0x3e63dc87,0x3e7fc568,0x3e8dbd62,0x3e9b7b85,0x3ea91a56,0x3ebd47db,0x3ed11f9b,0x3ee49898
.long 0x3ede2602,0x3ef7aa01,0x3f083341,0x3f1423cd,0x3f083341,0x3f170daa,0x3f2529fe,0x3f32767c
.long 0x3f1f9d07,0x3f2fdf08,0x3f3ee268,0x3f4c8bf3,0x3f3504f3,0x3f45e403,0x3f54db31,0x3f61c598
.long 0x3f48261c,0x3f58c2eb,0x3f66a5e5,0x3f71a257,0x3f58c2eb,0x3f682ee0,0x3f73e912,0x3f7bc1bb
.long 0x3f66a5e5,0x3f73e912,0x3f7c620b,0x3f7fe638,0x3f71a257,0x3f7bc1bb,0x3f7fe638,0x3f7df69c
.long 0x3f7994e0,0x3f7f98e6,0x3f7e63ec,0x3f75fead,0x3f7e63ec,0x3f7f5eee,0x3f77e2bd,0x3f682ee0
.long 0x3f800000,0x3f7b14be,0x3f6c835e,0x3f54db31,0x3f7e63ec,0x3f72cbd1,0x3f5c7efc,0x3f3c7927
.long 0,0,0,0,0x3e2b86c0,0x3e39aaee,0x3e47c5c2,0x3e55d687
.long 0x3ea91a56,0x3eb69719,0x3ec3ef15,0x3ed11f9b,0x3ef7aa01,0x3f052598,0x3f0e39da,0x3f170daa
.long 0x3f1f9d07,0x3f2a95b0,0x3f3504f3,0x3f3ee268,0x3f3ee268,0x3f4a5e20,0x3f54db31,0x3f5e4c69
.long 0x3f58c2eb,0x3f63712c,0x3f6c835e,0x3f73e912,0x3f6c835e,0x3f74fa0b,0x3f7b14be,0x3f7ec46d
.long 0x3f7994e0,0x3f7e63ec,0x3f800000,0x3f7e63ec,0x3f7f98e6,0x3f7f5eee,0x3f7b14be,0x3f72cbd1
.long 0x3f7e63ec,0x3f77e2bd,0x3f6c835e,0x3f5c7efc,0x3f75fead,0x3f682ee0,0x3f54db31,0x3f3c7927
.long 0x3f66a5e5,0x3f50c899,0x3f3504f3,0x3f1423cd,0x3f50c899,0x3f32767c,0x3f0e39da,0x3eca8c72
.long 0x3f3504f3,0x3f0e39da,0x3ec3ef15,0x3e47c5c2,0x3f1423cd,0x3eca8c72,0x3e47c5c2,0xbc65c70c
.long 0x3f80,0x3f80,0x3f80,0x3f80,0x3f80,0x3f80,0x3f80,0x3f80
.long 0,0,0,0,0,0,0,0
.long 0x3f80,0xbf80,0x3f80,0xbf80,0x3f80,0xbf80,0x3f80,0xbf80
.long 0,0x8000,0,0x8000,0,0x8000,0,0x8000
.long 0,0,0,0,0,0,0,0
.long 0x3f80,0x3f80,0x3f80,0x3f80,0x3f80,0x3f80,0x3f80,0x3f80
.long 0,0x8000,0,0x8000,0,0x8000,0,0x8000
.long 0x3f80,0xbf80,0x3f80,0xbf80,0x3f80,0xbf80,0x3f80,0xbf80
.long 0x3f80,0x3f353f35,0x3f800000,0x3f35bf35,0xbf80,0xbf35bf35,0xbf800000,0xbf353f35
.long 0,0,0,0x8000,0x8000,0x80008000,0x80000000,0x80000000
.long 0x3f80,0xbf35bf35,0x3f800000,0xbf353f35,0xbf80,0x3f353f35,0xbf800000,0x3f35bf35
.long 0,0x80008000,0,0x80000000,0x8000,0,0x80000000,0x8000
.long 0,0,0,0x8000,0x8000,0x80008000,0x80000000,0x80000000
.long 0x3f80,0x3f353f35,0x3f800000,0x3f35bf35,0xbf80,0xbf35bf35,0xbf800000,0xbf353f35
.long 0,0x80008000,0,0x80000000,0x8000,0,0x80000000,0x8000
.long 0x3f80,0xbf35bf35,0x3f800000,0xbf353f35,0xbf80,0x3f353f35,0xbf800000,0x3f35bf35
.long 0x3f80,0x3f800000,0xbf80,0xbf800000,0x3f80,0x3f800000,0xbf80,0xbf800000
.long 0,0,0x8000,0x80000000,0,0,0x8000,0x80000000
.long 0x3f80,0xbf800000,0xbf80,0x3f800000,0x3f80,0xbf800000,0xbf80,0x3f800000
.long 0,0x80000000,0x8000,0,0,0x80000000,0x8000,0
.long 0,0,0x8000,0x80000000,0,0,0x8000,0x80000000
.long 0x3f80,0x3f800000,0xbf80,0xbf800000,0x3f80,0x3f800000,0xbf80,0xbf800000
.long 0,0x80000000,0x8000,0,0,0x80000000,0x8000,0
.long 0x3f80,0xbf800000,0xbf80,0x3f800000,0x3f80,0xbf800000,0xbf80,0x3f800000
.long 0x3f80,0x3f35bf35,0xbf800000,0x3f353f35,0xbf80,0xbf353f35,0x3f800000,0xbf35bf35
.long 0,0x8000,0x80000000,0,0x8000,0x80000000,0,0x80008000
.long 0x3f80,0xbf353f35,0xbf800000,0xbf35bf35,0xbf80,0x3f35bf35,0x3f800000,0x3f353f35
.long 0,0x80000000,0x80000000,0x80008000,0x8000,0x8000,0,0
.long 0,0x8000,0x80000000,0,0x8000,0x80000000,0,0x80008000
.long 0x3f80,0x3f35bf35,0xbf800000,0x3f353f35,0xbf80,0xbf353f35,0x3f800000,0xbf35bf35
.long 0,0x80000000,0x80000000,0x80008000,0x8000,0x8000,0,0
.long 0x3f80,0xbf353f35,0xbf800000,0xbf35bf35,0xbf80,0x3f35bf35,0x3f800000,0x3f353f35
.long 0x3f808000,0x3f808000,0x3f808000,0x3f808000,0x3f808000,0x3f808000,0x3f808000,0x3f808000
.long 0x8000,0x8000,0x8000,0x8000,0x8000,0x8000,0x8000,0x8000
.long 0x3f808000,0xbf808000,0x3f808000,0xbf808000,0x3f808000,0xbf808000,0x3f808000,0xbf808000
.long 0x8000,0x80008000,0x8000,0x80008000,0x8000,0x80008000,0x8000,0x80008000
.long 0x8000,0x8000,0x8000,0x8000,0x8000,0x8000,0x8000,0x8000
.long 0x3f808000,0x3f808000,0x3f808000,0x3f808000,0x3f808000,0x3f808000,0x3f808000,0x3f808000
.long 0x8000,0x80008000,0x8000,0x80008000,0x8000,0x80008000,0x8000,0x80008000
.long 0x3f808000,0xbf808000,0x3f808000,0xbf808000,0x3f808000,0xbf808000,0x3f808000,0xbf808000
.long 0x3f808000,0x3f35bf35,0xbf80,0xbf35bf35,0xbf808000,0xbf353f35,0x3f80,0x3f353f35
.long 0x8000,0x8000,0x8000,0x80008000,0x80008000,0x80000000,0,0
.long 0x3f808000,0xbf353f35,0xbf80,0x3f353f35,0xbf808000,0x3f35bf35,0x3f80,0xbf35bf35
.long 0x8000,0x80000000,0x8000,0,0x80008000,0x8000,0,0x80008000
.long 0x8000,0x8000,0x8000,0x80008000,0x80008000,0x80000000,0,0
.long 0x3f808000,0x3f35bf35,0xbf80,0xbf35bf35,0xbf808000,0xbf353f35,0x3f80,0x3f353f35
.long 0x8000,0x80000000,0x8000,0,0x80008000,0x8000,0,0x80008000
.long 0x3f808000,0xbf353f35,0xbf80,0x3f353f35,0xbf808000,0x3f35bf35,0x3f80,0xbf35bf35
.long 0x3f808000,0xbf80,0xbf808000,0x3f80,0x3f808000,0xbf80,0xbf808000,0x3f80
.long 0x8000,0x8000,0x80008000,0,0x8000,0x8000,0x80008000,0
.long 0x3f808000,0x3f80,0xbf808000,0xbf80,0x3f808000,0x3f80,0xbf808000,0xbf80
.long 0x8000,0,0x80008000,0x8000,0x8000,0,0x80008000,0x8000
.long 0x8000,0x8000,0x80008000,0,0x8000,0x8000,0x80008000,0
.long 0x3f808000,0xbf80,0xbf808000,0x3f80,0x3f808000,0xbf80,0xbf808000,0x3f80
.long 0x8000,0,0x80008000,0x8000,0x8000,0,0x80008000,0x8000
.long 0x3f808000,0x3f80,0xbf808000,0xbf80,0x3f808000,0x3f80,0xbf808000,0xbf80
.long 0x3f808000,0xbf35bf35,0x3f80,0x3f35bf35,0xbf808000,0x3f353f35,0xbf80,0xbf353f35
.long 0x8000,0x80008000,0,0x8000,0x80008000,0,0x8000,0x80000000
.long 0x3f808000,0x3f353f35,0x3f80,0xbf353f35,0xbf808000,0xbf35bf35,0xbf80,0x3f35bf35
.long 0x8000,0,0,0x80000000,0x80008000,0x80008000,0x8000,0x8000
.long 0x8000,0x80008000,0,0x8000,0x80008000,0,0x8000,0x80000000
.long 0x3f808000,0xbf35bf35,0x3f80,0x3f35bf35,0xbf808000,0x3f353f35,0xbf80,0xbf353f35
.long 0x8000,0,0,0x80000000,0x80008000,0x80008000,0x8000,0x8000
.long 0x3f808000,0x3f353f35,0x3f80,0xbf353f35,0xbf808000,0xbf35bf35,0xbf80,0x3f35bf35
.long 0x80003f80,0x80003f80,0x80003f80,0x80003f80,0x80003f80,0xbf353f35,0xbf800000,0xbf35bf35
.long 0x80003f80,0xbf800000,0x8000bf80,0x3f800000,0x80003f80,0xbf35bf35,0x3f800000,0xbf353f35
.long 0x80003f80,0x8000bf80,0x80003f80,0x8000bf80,0x80003f80,0x3f35bf35,0xbf800000,0x3f353f35
.long 0x80003f80,0x3f800000,0x8000bf80,0xbf800000,0x80003f80,0x3f353f35,0x3f800000,0x3f35bf35
.long 0x80000000,0x80000000,0x80000000,0x80000000,0x80000000,0x80000000,0x80000000,0x80008000
.long 0x80000000,0x80000000,0x80008000,0,0x80000000,0x80008000,0,0x80000000
.long 0x80000000,0x80008000,0x80000000,0x80008000,0x80000000,0x8000,0x80000000,0
.long 0x80000000,0,0x80008000,0x80000000,0x80000000,0,0,0x8000
.long 0x80003f80,0x80003f80,0x80003f80,0x80003f80,0x8000bf80,0x3f35bf35,0x3f800000,0x3f353f35
.long 0x80003f80,0xbf800000,0x8000bf80,0x3f800000,0x8000bf80,0x3f353f35,0xbf800000,0x3f35bf35
.long 0x80003f80,0x8000bf80,0x80003f80,0x8000bf80,0x8000bf80,0xbf353f35,0x3f800000,0xbf35bf35
.long 0x80003f80,0x3f800000,0x8000bf80,0xbf800000,0x8000bf80,0xbf35bf35,0xbf800000,0xbf353f35
.long 0x80000000,0x80000000,0x80000000,0x80000000,0x80008000,0x8000,0,0
.long 0x80000000,0x80000000,0x80008000,0,0x80008000,0,0x80000000,0x8000
.long 0x80000000,0x80008000,0x80000000,0x80008000,0x80008000,0x80000000,0,0x80008000
.long 0x80000000,0,0x80008000,0x80000000,0x80008000,0x80008000,0x80000000,0x80000000
.long 0x80000000,0x80000000,0x80000000,0x80000000,0x80000000,0x80000000,0x80000000,0x80008000
.long 0x80000000,0x80000000,0x80008000,0,0x80000000,0x80008000,0,0x80000000
.long 0x80000000,0x80008000,0x80000000,0x80008000,0x80000000,0x8000,0x80000000,0
.long 0x80000000,0,0x80008000,0x80000000,0x80000000,0,0,0x8000
.long 0x80003f80,0x80003f80,0x80003f80,0x80003f80,0x80003f80,0xbf353f35,0xbf800000,0xbf35bf35
.long 0x80003f80,0xbf800000,0x8000bf80,0x3f800000,0x80003f80,0xbf35bf35,0x3f800000,0xbf353f35
.long 0x80003f80,0x8000bf80,0x80003f80,0x8000bf80,0x80003f80,0x3f35bf35,0xbf800000,0x3f353f35
.long 0x80003f80,0x3f800000,0x8000bf80,0xbf800000,0x80003f80,0x3f353f35,0x3f800000,0x3f35bf35
.long 0x80000000,0x80000000,0x80000000,0x80000000,0x80008000,0x8000,0,0
.long 0x80000000,0x80000000,0x80008000,0,0x80008000,0,0x80000000,0x8000
.long 0x80000000,0x80008000,0x80000000,0x80008000,0x80008000,0x80000000,0,0x80008000
.long 0x80000000,0,0x80008000,0x80000000,0x80008000,0x80008000,0x80000000,0x80000000
.long 0x80003f80,0x80003f80,0x80003f80,0x80003f80,0x8000bf80,0x3f35bf35,0x3f800000,0x3f353f35
.long 0x80003f80,0xbf800000,0x8000bf80,0x3f800000,0x8000bf80,0x3f353f35,0xbf800000,0x3f35bf35
.long 0x80003f80,0x8000bf80,0x80003f80,0x8000bf80,0x8000bf80,0xbf353f35,0x3f800000,0xbf35bf35
.long 0x80003f80,0x3f800000,0x8000bf80,0xbf800000,0x8000bf80,0xbf35bf35,0xbf800000,0xbf353f35
.long 0x3f800000,0x3f800000,0x3f800000,0x3f800000,0x3f800000,0x3f353f35,0x3f80,0xbf353f35
.long 0x3f800000,0x3f80,0xbf800000,0xbf80,0x3f800000,0xbf353f35,0xbf80,0x3f353f35
.long 0x3f800000,0xbf800000,0x3f800000,0xbf800000,0x3f800000,0xbf35bf35,0x3f80,0x3f35bf35
.long 0x3f800000,0xbf80,0xbf800000,0x3f80,0x3f800000,0x3f35bf35,0xbf80,0xbf35bf35
.long 0,0,0,0,0,0,0,0x80000000
.long 0,0,0x80000000,0x8000,0,0x80000000,0x8000,0
.long 0,0x80000000,0,0x80000000,0,0x80008000,0,0x8000
.long 0,0x8000,0x80000000,0,0,0x8000,0x8000,0x80008000
.long 0x3f800000,0x3f800000,0x3f800000,0x3f800000,0xbf800000,0xbf35bf35,0xbf80,0x3f35bf35
.long 0x3f800000,0x3f80,0xbf800000,0xbf80,0xbf800000,0x3f35bf35,0x3f80,0xbf35bf35
.long 0x3f800000,0xbf800000,0x3f800000,0xbf800000,0xbf800000,0x3f353f35,0xbf80,0xbf353f35
.long 0x3f800000,0xbf80,0xbf800000,0x3f80,0xbf800000,0xbf353f35,0x3f80,0x3f353f35
.long 0,0,0,0,0x80000000,0x80008000,0x8000,0x8000
.long 0,0,0x80000000,0x8000,0x80000000,0x8000,0,0x80008000
.long 0,0x80000000,0,0x80000000,0x80000000,0,0x8000,0x80000000
.long 0,0x8000,0x80000000,0,0x80000000,0x80000000,0,0
.long 0,0,0,0,0,0,0,0x80000000
.long 0,0,0x80000000,0x8000,0,0x80000000,0x8000,0
.long 0,0x80000000,0,0x80000000,0,0x80008000,0,0x8000
.long 0,0x8000,0x80000000,0,0,0x8000,0x8000,0x80008000
.long 0x3f800000,0x3f800000,0x3f800000,0x3f800000,0x3f800000,0x3f353f35,0x3f80,0xbf353f35
.long 0x3f800000,0x3f80,0xbf800000,0xbf80,0x3f800000,0xbf353f35,0xbf80,0x3f353f35
.long 0x3f800000,0xbf800000,0x3f800000,0xbf800000,0x3f800000,0xbf35bf35,0x3f80,0x3f35bf35
.long 0x3f800000,0xbf80,0xbf800000,0x3f80,0x3f800000,0x3f35bf35,0xbf80,0xbf35bf35
.long 0,0,0,0,0x80000000,0x80008000,0x8000,0x8000
.long 0,0,0x80000000,0x8000,0x80000000,0x8000,0,0x80008000
.long 0,0x80000000,0,0x80000000,0x80000000,0,0x8000,0x80000000
.long 0,0x8000,0x80000000,0,0x80000000,0x80000000,0,0
.long 0x3f800000,0x3f800000,0x3f800000,0x3f800000,0xbf800000,0xbf35bf35,0xbf80,0x3f35bf35
.long 0x3f800000,0x3f80,0xbf800000,0xbf80,0xbf800000,0x3f35bf35,0x3f80,0xbf35bf35
.long 0x3f800000,0xbf800000,0x3f800000,0xbf800000,0xbf800000,0x3f353f35,0xbf80,0xbf353f35
.long 0x3f800000,0xbf80,0xbf800000,0x3f80,0xbf800000,0xbf353f35,0x3f80,0x3f353f35
.long 0x80003f80,0x80003f80,0x80003f80,0x80003f80,0x80003f80,0xbec43f6d,0xbf353f35,0xbf6d3ec4
.long 0x80003f80,0xbf353f35,0xbf800000,0xbf35bf35,0x80003f80,0xbf6d3ec4,0xbf35bf35,0x3ec4bf6d
.long 0x80003f80,0xbf800000,0x8000bf80,0x3f800000,0x80003f80,0xbf6dbec4,0x3f35bf35,0x3ec43f6d
.long 0x80003f80,0xbf35bf35,0x3f800000,0xbf353f35,0x80003f80,0xbec4bf6d,0x3f353f35,0xbf6dbec4
.long 0x80003f80,0x8000bf80,0x80003f80,0x8000bf80,0x80003f80,0x3ec4bf6d,0xbf353f35,0x3f6dbec4
.long 0x80003f80,0x3f35bf35,0xbf800000,0x3f353f35,0x80003f80,0x3f6dbec4,0xbf35bf35,0xbec43f6d
.long 0x80003f80,0x3f800000,0x8000bf80,0xbf800000,0x80003f80,0x3f6d3ec4,0x3f35bf35,0xbec4bf6d
.long 0x80003f80,0x3f353f35,0x3f800000,0x3f35bf35,0x80003f80,0x3ec43f6d,0x3f353f35,0x3f6d3ec4
.long 0x80003f80,0x80003f80,0x80003f80,0x80003f80,0xbf800000,0xbf6dbec4,0xbf35bf35,0xbec4bf6d
.long 0x8000bf80,0x3f35bf35,0x3f800000,0x3f353f35,0x3f800000,0x3ec43f6d,0xbf353f35,0xbf6dbec4
.long 0x80003f80,0xbf800000,0x8000bf80,0x3f800000,0xbf800000,0x3ec4bf6d,0x3f353f35,0xbf6d3ec4
.long 0x8000bf80,0x3f353f35,0xbf800000,0x3f35bf35,0x3f800000,0xbf6d3ec4,0x3f35bf35,0xbec43f6d
.long 0x80003f80,0x8000bf80,0x80003f80,0x8000bf80,0xbf800000,0x3f6d3ec4,0xbf35bf35,0x3ec43f6d
.long 0x8000bf80,0xbf353f35,0x3f800000,0xbf35bf35,0x3f800000,0xbec4bf6d,0xbf353f35,0x3f6d3ec4
.long 0x80003f80,0x3f800000,0x8000bf80,0xbf800000,0xbf800000,0xbec43f6d,0x3f353f35,0x3f6dbec4
.long 0x8000bf80,0xbf35bf35,0xbf800000,0xbf353f35,0x3f800000,0x3f6dbec4,0x3f35bf35,0x3ec4bf6d
.long 0x3f80,0x3f80,0x3f80,0x3f80,0xbf80,0xbec4bf6d,0xbf35bf35,0xbf6dbec4
.long 0x3f80,0x3f353f35,0x3f800000,0x3f35bf35,0xbf80,0xbf6dbec4,0xbf353f35,0x3ec43f6d
.long 0x3f80,0x3f800000,0xbf80,0xbf800000,0xbf80,0xbf6d3ec4,0x3f353f35,0x3ec4bf6d
.long 0x3f80,0x3f35bf35,0xbf800000,0x3f353f35,0xbf80,0xbec43f6d,0x3f35bf35,0xbf6d3ec4
.long 0x3f80,0xbf80,0x3f80,0xbf80,0xbf80,0x3ec43f6d,0xbf35bf35,0x3f6d3ec4
.long 0x3f80,0xbf35bf35,0x3f800000,0xbf353f35,0xbf80,0x3f6d3ec4,0xbf353f35,0xbec4bf6d
.long 0x3f80,0xbf800000,0xbf80,0x3f800000,0xbf80,0x3f6dbec4,0x3f353f35,0xbec43f6d
.long 0x3f80,0xbf353f35,0xbf800000,0xbf35bf35,0xbf80,0x3ec4bf6d,0x3f35bf35,0x3f6dbec4
.long 0x3f80,0x3f80,0x3f80,0x3f80,0xbf800000,0xbf6d3ec4,0xbf353f35,0xbec43f6d
.long 0xbf80,0xbf35bf35,0xbf800000,0xbf353f35,0x3f800000,0x3ec4bf6d,0xbf35bf35,0xbf6d3ec4
.long 0x3f80,0x3f800000,0xbf80,0xbf800000,0xbf800000,0x3ec43f6d,0x3f35bf35,0xbf6dbec4
.long 0xbf80,0xbf353f35,0x3f800000,0xbf35bf35,0x3f800000,0xbf6dbec4,0x3f353f35,0xbec4bf6d
.long 0x3f80,0xbf80,0x3f80,0xbf80,0xbf800000,0x3f6dbec4,0xbf353f35,0x3ec4bf6d
.long 0xbf80,0x3f353f35,0xbf800000,0x3f35bf35,0x3f800000,0xbec43f6d,0xbf35bf35,0x3f6dbec4
.long 0x3f80,0xbf800000,0xbf80,0x3f800000,0xbf800000,0xbec4bf6d,0x3f35bf35,0x3f6d3ec4
.long 0xbf80,0x3f35bf35,0x3f800000,0x3f353f35,0x3f800000,0x3f6d3ec4,0x3f353f35,0x3ec43f6d
.long 0x3f800000,0x3f800000,0x3f800000,0x3f800000,0x3f800000,0x3f6d3ec4,0x3f353f35,0x3ec43f6d
.long 0x3f800000,0x3f353f35,0x3f80,0xbf353f35,0x3f800000,0x3ec43f6d,0xbf353f35,0xbf6dbec4
.long 0x3f800000,0x3f80,0xbf800000,0xbf80,0x3f800000,0xbec43f6d,0xbf35bf35,0x3f6dbec4
.long 0x3f800000,0xbf353f35,0xbf80,0x3f353f35,0x3f800000,0xbf6d3ec4,0x3f35bf35,0xbec43f6d
.long 0x3f800000,0xbf800000,0x3f800000,0xbf800000,0x3f800000,0xbf6dbec4,0x3f353f35,0xbec4bf6d
.long 0x3f800000,0xbf35bf35,0x3f80,0x3f35bf35,0x3f800000,0xbec4bf6d,0xbf353f35,0x3f6d3ec4
.long 0x3f800000,0xbf80,0xbf800000,0x3f80,0x3f800000,0x3ec4bf6d,0xbf35bf35,0xbf6d3ec4
.long 0x3f800000,0x3f35bf35,0xbf80,0xbf35bf35,0x3f800000,0x3f6dbec4,0x3f35bf35,0x3ec4bf6d
.long 0x3f800000,0x3f800000,0x3f800000,0x3f800000,0x3f80,0xbec43f6d,0xbf353f35,0xbf6d3ec4
.long 0xbf800000,0xbf35bf35,0xbf80,0x3f35bf35,0xbf80,0x3f6dbec4,0x3f353f35,0xbec43f6d
.long 0x3f800000,0x3f80,0xbf800000,0xbf80,0x3f80,0xbf6dbec4,0x3f35bf35,0x3ec43f6d
.long 0xbf800000,0x3f35bf35,0x3f80,0xbf35bf35,0xbf80,0x3ec43f6d,0xbf35bf35,0x3f6d3ec4
.long 0x3f800000,0xbf800000,0x3f800000,0xbf800000,0x3f80,0x3ec4bf6d,0xbf353f35,0x3f6dbec4
.long 0xbf800000,0x3f353f35,0xbf80,0xbf353f35,0xbf80,0xbf6d3ec4,0x3f353f35,0x3ec4bf6d
.long 0x3f800000,0xbf80,0xbf800000,0x3f80,0x3f80,0x3f6d3ec4,0x3f35bf35,0xbec4bf6d
.long 0xbf800000,0xbf353f35,0x3f80,0x3f353f35,0xbf80,0xbec4bf6d,0xbf35bf35,0xbf6dbec4
.long 0xbf800000,0xbf800000,0xbf800000,0xbf800000,0x3f800000,0x3f6dbec4,0x3f35bf35,0x3ec4bf6d
.long 0xbf800000,0xbf353f35,0x80003f80,0x3f353f35,0x3f800000,0x3ec4bf6d,0xbf35bf35,0xbf6d3ec4
.long 0xbf800000,0x80003f80,0x3f800000,0x8000bf80,0x3f800000,0xbec4bf6d,0xbf353f35,0x3f6d3ec4
.long 0xbf800000,0x3f353f35,0x8000bf80,0xbf353f35,0x3f800000,0xbf6dbec4,0x3f353f35,0xbec4bf6d
.long 0xbf800000,0x3f800000,0xbf800000,0x3f800000,0x3f800000,0xbf6d3ec4,0x3f35bf35,0xbec43f6d
.long 0xbf800000,0x3f35bf35,0x80003f80,0xbf35bf35,0x3f800000,0xbec43f6d,0xbf35bf35,0x3f6dbec4
.long 0xbf800000,0x8000bf80,0x3f800000,0x80003f80,0x3f800000,0x3ec43f6d,0xbf353f35,0xbf6dbec4
.long 0xbf800000,0xbf35bf35,0x8000bf80,0x3f35bf35,0x3f800000,0x3f6d3ec4,0x3f353f35,0x3ec43f6d
.long 0xbf800000,0xbf800000,0xbf800000,0xbf800000,0x8000bf80,0xbec4bf6d,0xbf35bf35,0xbf6dbec4
.long 0x3f800000,0x3f35bf35,0x8000bf80,0xbf35bf35,0x80003f80,0x3f6d3ec4,0x3f35bf35,0xbec4bf6d
.long 0xbf800000,0x80003f80,0x3f800000,0x8000bf80,0x8000bf80,0xbf6d3ec4,0x3f353f35,0x3ec4bf6d
.long 0x3f800000,0xbf35bf35,0x80003f80,0x3f35bf35,0x80003f80,0x3ec4bf6d,0xbf353f35,0x3f6dbec4
.long 0xbf800000,0x3f800000,0xbf800000,0x3f800000,0x8000bf80,0x3ec43f6d,0xbf35bf35,0x3f6d3ec4
.long 0x3f800000,0xbf353f35,0x8000bf80,0x3f353f35,0x80003f80,0xbf6dbec4,0x3f35bf35,0x3ec43f6d
.long 0xbf800000,0x8000bf80,0x3f800000,0x80003f80,0x8000bf80,0x3f6dbec4,0x3f353f35,0xbec43f6d
.long 0x3f800000,0x3f353f35,0x80003f80,0xbf353f35,0x80003f80,0xbec43f6d,0xbf353f35,0xbf6d3ec4
.long 0x35924925,0x35924925,0x35924925,0x35924925,0x35924925,0x35924576,0x35923a69,0x35922800
.long 0x35924925,0x35923a69,0x35920e3a,0x3591c4a1,0x35924925,0x35922800,0x3591c4a1,0x35911f35
.long 0x35924925,0x35920e3a,0x35915dac,0x35903806,0x35924925,0x3591ed1a,0x3590d96f,0x358f0f7e
.long 0x35924925,0x3591c4a1,0x35903806,0x358da623,0x35924925,0x359194d1,0x358f7991,0x358bfc98
.long 0x35924925,0x35915dac,0x358e9e37,0x358a139f,0x35924925,0x35911f35,0x358da623,0x3587ec15
.long 0x35924925,0x3590d96f,0x358c9188,0x358586f3,0x35924925,0x35908c5e,0x358b609d,0x3582e551
.long 0x35924925,0x35903806,0x358a139f,0x3580085e,0x35924925,0x358fdc6b,0x3588aad2,0x3579e2ce
.long 0x35924925,0x358f7991,0x3587267f,0x357343a6,0x35924925,0x358f0f7e,0x358586f3,0x356c3643
.long 0x35924925,0x35924925,0x35924925,0x35924925,0x35920e3a,0x3591ed1a,0x3591c4a1,0x359194d1
.long 0x35915dac,0x3590d96f,0x35903806,0x358f7991,0x35903806,0x358f0f7e,0x358da623,0x358bfc98
.long 0x358e9e37,0x358c9188,0x358a139f,0x3587267f,0x358c9188,0x358962ae,0x358586f3,0x35810332
.long 0x358a139f,0x358586f3,0x3580085e,0x357343a6,0x3587267f,0x35810332,0x357343a6,0x35622928
.long 0x3583cc83,0x3577ba31,0x3564bdd6,0x354ee116,0x3580085e,0x356c3643,0x3554999d,0x35399af8
.long 0x3577ba31,0x355f8917,0x3542f437,0x35228b42,0x356e9c1c,0x3551c2a1,0x352fed9f,0x3509eacf
.long 0x3564bdd6,0x3542f437,0x351ba84a,0x34dfecab,0x355a2752,0x3533307b,0x350648f4,0x34a9dba6
.long 0x354ee116,0x35228b42,0x34dfecab,0x34644fb9,0x3542f437,0x3511197f,0x34b1b1bc,0x33e56a87
.long 0x35924925,0x35924925,0x35924925,0x35924925,0x35915dac,0x35911f35,0x3590d96f,0x35908c5e
.long 0x358e9e37,0x358da623,0x358c9188,0x358b609d,0x358a139f,0x3587ec15,0x358586f3,0x3582e551
.long 0x3583cc83,0x3580085e,0x3577ba31,0x356e9c1c,0x3577ba31,0x356c3643,0x355f8917,0x3551c2a1
.long 0x3564bdd6,0x3554999d,0x3542f437,0x352fed9f,0x354ee116,0x35399af8,0x35228b42,0x3509eacf
.long 0x35366a51,0x351ba84a,0x34fde24c,0x34c142ac,0x351ba84a,0x34f67721,0x34b1b1bc,0x34543110
.long 0x34fde24c,0x34b1b1bc,0x344407b7,0x330349dd,0x34c142ac,0x34543110,0x330349dd,0xb41353b8
.long 0x348234df,0x33833ca5,0xb40307ca,0xb4a1fd03,0x340307ca,0xb3a3ff69,0xb49227a9,0xb4f67721
.long 0,0xb4644fb9,0xb4dfecab,0xb5228b42,0xb40307ca,0xb4b97ee0,0xb514a5f9,0xb545fe8a
.long 0x35924925,0x35924925,0x35924925,0x35924925,0x35903806,0x358fdc6b,0x358f7991,0x358f0f7e
.long 0x358a139f,0x3588aad2,0x3587267f,0x358586f3,0x3580085e,0x3579e2ce,0x357343a6,0x356c3643
.long 0x3564bdd6,0x355a2752,0x354ee116,0x3542f437,0x3542f437,0x3533307b,0x35228b42,0x3511197f
.long 0x351ba84a,0x350648f4,0x34dfecab,0x34b1b1bc,0x34dfecab,0x34a9dba6,0x34644fb9,0x33e56a87
.long 0x348234df,0x340307ca,0,0xb40307ca,0x33833ca5,0xb3a3ff69,0xb4644fb9,0xb4b97ee0
.long 0xb40307ca,0xb49227a9,0xb4dfecab,0xb514a5f9,0xb4a1fd03,0xb4f67721,0xb5228b42,0xb545fe8a
.long 0xb4fde24c,0xb5294d7d,0xb54ee116,0xb56e9c1c,0xb5294d7d,0xb551c2a1,0xb57343a6,0xb5865a1b
.long 0xb54ee116,0xb57343a6,0xb587267f,0xb58f7991,0xb56e9c1c,0xb5865a1b,0xb58f7991,0xb5924576
.long 0,0,0,0,0,0x32834d2c,0x330349dd,0x3344e688
.long 0,0x330349dd,0x33833ca5,0x33c4b9ec,0,0x3344e688,0x33c4b9ec,0x341353b8
.long 0,0x33833ca5,0x340307ca,0x344407b7,0,0x33a3ff69,0x3423983a,0x347462e3
.long 0,0x33c4b9ec,0x344407b7,0x349227a9,0,0x33e56a87,0x34644fb9,0x34a9dba6
.long 0,0x340307ca,0x348234df,0x34c142ac,0,0x341353b8,0x349227a9,0x34d8521f
.long 0,0x3423983a,0x34a1fd03,0x34eeff8d,0,0x3433d480,0x34b1b1bc,0x3502a057
.long 0,0x344407b7,0x34c142ac,0x350d85b7,0,0x34543110,0x34d0acaf,0x35182af6
.long 0,0x34644fb9,0x34dfecab,0x35228b42,0,0x347462e3,0x34eeff8d,0x352ca1e6
.long 0,0,0,0,0x33833ca5,0x33a3ff69,0x33c4b9ec,0x33e56a87
.long 0x340307ca,0x3423983a,0x344407b7,0x34644fb9,0x344407b7,0x347462e3,0x349227a9,0x34a9dba6
.long 0x348234df,0x34a1fd03,0x34c142ac,0x34dfecab,0x34a1fd03,0x34c8fcbd,0x34eeff8d,0x3509eacf
.long 0x34c142ac,0x34eeff8d,0x350d85b7,0x35228b42,0x34dfecab,0x3509eacf,0x35228b42,0x35399af8
.long 0x34fde24c,0x351ba84a,0x35366a51,0x354ee116,0x350d85b7,0x352ca1e6,0x3548fee4,0x35622928
.long 0x351ba84a,0x353cc247,0x355a2752,0x357343a6,0x35294d7d,0x354bf520,0x3569c484,0x35810332
.long 0x35366a51,0x355a2752,0x3577ba31,0x3587267f,0x3542f437,0x35674700,0x3581f787,0x358bfc98
.long 0x354ee116,0x357343a6,0x3587267f,0x358f7991,0x355a2752,0x357e0e2f,0x358b609d,0x359194d1
.long 0,0,0,0,0x340307ca,0x341353b8,0x3423983a,0x3433d480
.long 0x348234df,0x349227a9,0x34a1fd03,0x34b1b1bc,0x34c142ac,0x34d8521f,0x34eeff8d,0x3502a057
.long 0x34fde24c,0x350d85b7,0x351ba84a,0x35294d7d,0x351ba84a,0x352ca1e6,0x353cc247,0x354bf520
.long 0x35366a51,0x3548fee4,0x355a2752,0x3569c484,0x354ee116,0x35622928,0x357343a6,0x35810332
.long 0x3564bdd6,0x3577ba31,0x3583cc83,0x358a139f,0x3577ba31,0x3584ad12,0x358b609d,0x358fdc6b
.long 0x3583cc83,0x358b609d,0x35903806,0x35923a69,0x358a139f,0x358fdc6b,0x35923a69,0x35911f35
.long 0x358e9e37,0x35920e3a,0x35915dac,0x358c9188,0x35915dac,0x3591ed1a,0x358da623,0x3584ad12
.long 0x35924925,0x358f7991,0x3587267f,0x357343a6,0x35915dac,0x358abd9c,0x357bfed7,0x355765e4
.long 0,0,0,0,0x344407b7,0x34543110,0x34644fb9,0x347462e3
.long 0x34c142ac,0x34d0acaf,0x34dfecab,0x34eeff8d,0x350d85b7,0x35182af6,0x35228b42,0x352ca1e6
.long 0x35366a51,0x3542f437,0x354ee116,0x355a2752,0x355a2752,0x35674700,0x357343a6,0x357e0e2f
.long 0x3577ba31,0x3581f787,0x3587267f,0x358b609d,0x3587267f,0x358bfc98,0x358f7991,0x359194d1
.long 0x358e9e37,0x35915dac,0x35924925,0x35915dac,0x35920e3a,0x3591ed1a,0x358f7991,0x358abd9c
.long 0x35915dac,0x358da623,0x3587267f,0x357bfed7,0x358c9188,0x3584ad12,0x357343a6,0x355765e4
.long 0x3583cc83,0x356e9c1c,0x354ee116,0x35294d7d,0x356e9c1c,0x354bf520,0x35228b42,0x34e77bf0
.long 0x354ee116,0x35228b42,0x34dfecab,0x34644fb9,0x35294d7d,0x34e77bf0,0x34644fb9,0xb2834d2c
.long 0x80003f80,0x80004000,0x80004000,0x80004000,0x80003f80,0xbee43ffa,0xbf5e3fe7,0xbfa03fc8
.long 0x80003f80,0xbf5e3fe7,0xbfc83fa0,0xbffa3ee4,0x80003f80,0xbfa03fc8,0xbffa3ee4,0xbfe7bf5e
.long 0x80003f80,0xbfc83fa0,0xbffabee4,0xbf5ebfe7,0x80003f80,0xbfe73f5e,0xbfc8bfa0,0x3ee4bffa
.long 0x80003f80,0xbffa3ee4,0xbf5ebfe7,0x3fc8bfa0,0x80003f80,0xc0000000,0x8000c000,0x40000000
.long 0x80003f80,0xbffabee4,0x3f5ebfe7,0x3fc83fa0,0x80003f80,0xbfe7bf5e,0x3fc8bfa0,0x3ee43ffa
.long 0x80003f80,0xbfc8bfa0,0x3ffabee4,0xbf5e3fe7,0x80003f80,0xbfa0bfc8,0x3ffa3ee4,0xbfe73f5e
.long 0x80003f80,0xbf5ebfe7,0x3fc83fa0,0xbffabee4,0x80003f80,0xbee4bffa,0x3f5e3fe7,0xbfa0bfc8
.long 0x80003f80,0x8000c000,0x80004000,0x8000c000,0x80003f80,0x3ee4bffa,0xbf5e3fe7,0x3fa0bfc8
.long 0x80004000,0x80004000,0x80004000,0x80004000,0xbfc83fa0,0xbfe73f5e,0xbffa3ee4,0xc0000000
.long 0xbffabee4,0xbfc8bfa0,0xbf5ebfe7,0x8000c000,0xbf5ebfe7,0x3ee4bffa,0x3fc8bfa0,0x40000000
.long 0x3f5ebfe7,0x3ffabee4,0x3fc83fa0,0x80004000,0x3ffabee4,0x3fa03fc8,0xbf5e3fe7,0xc0000000
.long 0x3fc83fa0,0xbf5e3fe7,0xbffabee4,0x8000c000,0x80004000,0xc0000000,0x8000c000,0x40000000
.long 0xbfc83fa0,0xbf5ebfe7,0x3ffabee4,0x80004000,0xbffabee4,0x3fa0bfc8,0x3f5e3fe7,0xc0000000
.long 0xbf5ebfe7,0x3ffa3ee4,0xbfc83fa0,0x8000c000,0x3f5ebfe7,0x3ee43ffa,0xbfc8bfa0,0x40000000
.long 0x3ffabee4,0xbfc83fa0,0x3f5ebfe7,0x80004000,0x3fc83fa0,0xbfe7bf5e,0x3ffa3ee4,0xc0000000
.long 0x80004000,0x8000c000,0x80004000,0x8000c000,0xbfc83fa0,0x3fe7bf5e,0xbffa3ee4,0x40000000
.long 0x80004000,0x80004000,0x80004000,0x80004000,0xbffabee4,0xbfe7bf5e,0xbfc8bfa0,0xbfa0bfc8
.long 0x3f5ebfe7,0x3fc8bfa0,0x3ffabee4,0x3ffa3ee4,0x3fc83fa0,0x3ee43ffa,0xbf5e3fe7,0xbfe73f5e
.long 0xbfc83fa0,0xbffabee4,0xbf5ebfe7,0x3f5ebfe7,0xbf5ebfe7,0x3fa0bfc8,0x3ffa3ee4,0x3ee43ffa
.long 0x3ffabee4,0x3f5e3fe7,0xbfc83fa0,0xbfc8bfa0,0x80004000,0xc0000000,0x8000c000,0x40000000
.long 0xbffabee4,0x3f5ebfe7,0x3fc83fa0,0xbfc83fa0,0x3f5ebfe7,0x3fa03fc8,0xbffa3ee4,0x3ee4bffa
.long 0x3fc83fa0,0xbffa3ee4,0x3f5ebfe7,0x3f5e3fe7,0xbfc83fa0,0x3ee4bffa,0x3f5e3fe7,0xbfe7bf5e
.long 0xbf5ebfe7,0x3fc83fa0,0xbffabee4,0x3ffabee4,0x3ffabee4,0xbfe73f5e,0x3fc8bfa0,0xbfa03fc8
.long 0x80004000,0x8000c000,0x80004000,0x8000c000,0xbffabee4,0x3fe73f5e,0xbfc8bfa0,0x3fa03fc8
.long 0x80004000,0x80004000,0x80003f80,0x80000000,0xbf5ebfe7,0xbee4bffa,0x8000bf80,0x8000
.long 0x3fc83fa0,0x3f5e3fe7,0x80003f80,0x80000000,0xbffabee4,0xbfa0bfc8,0x8000bf80,0x8000
.long 0x3ffabee4,0x3fc83fa0,0x80003f80,0x80000000,0xbfc83fa0,0xbfe7bf5e,0x8000bf80,0x8000
.long 0x3f5ebfe7,0x3ffa3ee4,0x80003f80,0x80000000,0x80004000,0xc0000000,0x8000bf80,0
.long 0xbf5ebfe7,0x3ffabee4,0x80003f80,0x80008000,0x3fc83fa0,0xbfe73f5e,0x8000bf80,0
.long 0xbffabee4,0x3fc8bfa0,0x80003f80,0x80008000,0x3ffabee4,0xbfa03fc8,0x8000bf80,0
.long 0xbfc83fa0,0x3f5ebfe7,0x80003f80,0x80008000,0x3f5ebfe7,0xbee43ffa,0x8000bf80,0
.long 0x80004000,0x8000c000,0x80003f80,0x80008000,0xbf5ebfe7,0x3ee43ffa,0x8000bf80,0x80000000
.long 0x80003f80,0x3f5ebfe7,0xbfc83fa0,0x3ffabee4,0x80003f80,0x3fa0bfc8,0xbffa3ee4,0x3fe73f5e
.long 0x80003f80,0x3fc8bfa0,0xbffabee4,0x3f5e3fe7,0x80003f80,0x3fe7bf5e,0xbfc8bfa0,0xbee43ffa
.long 0x80003f80,0x3ffabee4,0xbf5ebfe7,0xbfc83fa0,0x80003f80,0x40000000,0x8000c000,0xc0000000
.long 0x80003f80,0x3ffa3ee4,0x3f5ebfe7,0xbfc8bfa0,0x80003f80,0x3fe73f5e,0x3fc8bfa0,0xbee4bffa
.long 0x80003f80,0x3fc83fa0,0x3ffabee4,0x3f5ebfe7,0x80003f80,0x3fa03fc8,0x3ffa3ee4,0x3fe7bf5e
.long 0x80003f80,0x3f5e3fe7,0x3fc83fa0,0x3ffa3ee4,0x80003f80,0x3ee43ffa,0x3f5e3fe7,0x3fa03fc8
.long 0x80003f80,0x80004000,0x80004000,0x80004000,0x80003f80,0xbee43ffa,0xbf5e3fe7,0xbfa03fc8
.long 0x80003f80,0xbf5e3fe7,0xbfc83fa0,0xbffa3ee4,0x80003f80,0xbfa03fc8,0xbffa3ee4,0xbfe7bf5e
.long 0xbffabee4,0x3fc83fa0,0xbf5ebfe7,0x80004000,0xbf5ebfe7,0xbee43ffa,0x3fc8bfa0,0xc0000000
.long 0x3f5ebfe7,0xbffa3ee4,0x3fc83fa0,0x8000c000,0x3ffabee4,0xbfa0bfc8,0xbf5e3fe7,0x40000000
.long 0x3fc83fa0,0x3f5ebfe7,0xbffabee4,0x80004000,0x80004000,0x40000000,0x8000c000,0xc0000000
.long 0xbfc83fa0,0x3f5e3fe7,0x3ffabee4,0x8000c000,0xbffabee4,0xbfa03fc8,0x3f5e3fe7,0x40000000
.long 0xbf5ebfe7,0xbffabee4,0xbfc83fa0,0x80004000,0x3f5ebfe7,0xbee4bffa,0xbfc8bfa0,0xc0000000
.long 0x3ffabee4,0x3fc8bfa0,0x3f5ebfe7,0x8000c000,0x3fc83fa0,0x3fe73f5e,0x3ffa3ee4,0x40000000
.long 0x80004000,0x80004000,0x80004000,0x80004000,0xbfc83fa0,0xbfe73f5e,0xbffa3ee4,0xc0000000
.long 0xbffabee4,0xbfc8bfa0,0xbf5ebfe7,0x8000c000,0xbf5ebfe7,0x3ee4bffa,0x3fc8bfa0,0x40000000
.long 0x3f5ebfe7,0xbfc83fa0,0x3ffabee4,0xbffabee4,0x3fc83fa0,0xbee4bffa,0xbf5e3fe7,0x3fe7bf5e
.long 0xbfc83fa0,0x3ffa3ee4,0xbf5ebfe7,0xbf5e3fe7,0xbf5ebfe7,0xbfa03fc8,0x3ffa3ee4,0xbee4bffa
.long 0x3ffabee4,0xbf5ebfe7,0xbfc83fa0,0x3fc83fa0,0x80004000,0x40000000,0x8000c000,0xc0000000
.long 0xbffabee4,0xbf5e3fe7,0x3fc83fa0,0x3fc8bfa0,0x3f5ebfe7,0xbfa0bfc8,0xbffa3ee4,0xbee43ffa
.long 0x3fc83fa0,0x3ffabee4,0x3f5ebfe7,0xbf5ebfe7,0xbfc83fa0,0xbee43ffa,0x3f5e3fe7,0x3fe73f5e
.long 0xbf5ebfe7,0xbfc8bfa0,0xbffabee4,0xbffa3ee4,0x3ffabee4,0x3fe7bf5e,0x3fc8bfa0,0x3fa0bfc8
.long 0x80004000,0x80004000,0x80004000,0x80004000,0xbffabee4,0xbfe7bf5e,0xbfc8bfa0,0xbfa0bfc8
.long 0x3f5ebfe7,0x3fc8bfa0,0x3ffabee4,0x3ffa3ee4,0x3fc83fa0,0x3ee43ffa,0xbf5e3fe7,0xbfe73f5e
.long 0x3fc83fa0,0xbf5ebfe7,0x80003f80,0x8000,0xbffabee4,0x3fa03fc8,0x8000bf80,0x80000000
.long 0x3ffabee4,0xbfc8bfa0,0x80003f80,0x8000,0xbfc83fa0,0x3fe73f5e,0x8000bf80,0x80000000
.long 0x3f5ebfe7,0xbffabee4,0x80003f80,0x8000,0x80004000,0x40000000,0x8000bf80,0x80000000
.long 0xbf5ebfe7,0xbffa3ee4,0x80003f80,0,0x3fc83fa0,0x3fe7bf5e,0x8000bf80,0x80008000
.long 0xbffabee4,0xbfc83fa0,0x80003f80,0,0x3ffabee4,0x3fa0bfc8,0x8000bf80,0x80008000
.long 0xbfc83fa0,0xbf5e3fe7,0x80003f80,0,0x3f5ebfe7,0x3ee4bffa,0x8000bf80,0x80008000
.long 0x80004000,0x80004000,0x80003f80,0x80000000,0xbf5ebfe7,0xbee4bffa,0x8000bf80,0x8000
.long 0x3fc83fa0,0x3f5e3fe7,0x80003f80,0x80000000,0xbffabee4,0xbfa0bfc8,0x8000bf80,0x8000
.long 0,0,0,0,0,0,0,0
.long 0,0,0,0,0,0,0,0
.long 0,0,0,0,0,0,0,0
.long 0,0,0,0,0,0,0,0
.long 0,0,0,0,0,0,0,0
.long 0,0,0,0,0,0,0,0
.long 0,0,0,0,0,0,0,0
.long 0,0,0,0,0,0,0,0
.long 0,0,0x3f803f80,0x3f803f80,0,0,0x3f800000,0x3f803f80
.long 0,0,0,0x3f803f80,0,0,0,0x3f800000
.long 0,0,0,0,0,0,0,0
.long 0,0,0,0,0,0,0,0
.long 0,0,0,0,0,0,0,0
.long 0,0,0,0,0,0,0,0
.long 0,0,0,0,0,0,0,0
.long 0,0,0,0,0,0,0,0
.long 0x3f803f80,0x3f803f80,0x3f80,0,0x3f803f80,0x3f803f80,0x3f803f80,0
.long 0x3f803f80,0x3f803f80,0x3f803f80,0x3f80,0x3f803f80,0x3f803f80,0x3f803f80,0x3f803f80
.long 0x3f803f80,0x3f803f80,0x3f803f80,0x3f803f80,0x3f800000,0x3f803f80,0x3f803f80,0x3f803f80
.long 0,0x3f803f80,0x3f803f80,0x3f803f80,0,0x3f800000,0x3f803f80,0x3f803f80
.long 0,0,0x3f803f80,0x3f803f80,0,0,0x3f800000,0x3f803f80
.long 0,0,0,0x3f803f80,0,0,0,0x3f800000
.long 0,0,0,0,0,0,0,0
.long 0,0,0,0,0,0,0,0
.long 0,0,0,0,0,0,0,0
.long 0,0,0,0,0,0,0,0
.long 0x3f80,0,0,0,0x3f803f80,0,0,0
.long 0x3f803f80,0x3f80,0,0,0x3f803f80,0x3f803f80,0,0
.long 0x3f803f80,0x3f803f80,0x3f80,0,0x3f803f80,0x3f803f80,0x3f803f80,0
.long 0x3f803f80,0x3f803f80,0x3f803f80,0x3f80,0x3f803f80,0x3f803f80,0x3f803f80,0x3f803f80
.long 0x3f803f80,0x3f803f80,0x3f803f80,0x3f803f80,0x3f800000,0x3f803f80,0x3f803f80,0x3f803f80
.long 0,0x3f803f80,0x3f803f80,0x3f803f80,0,0x3f800000,0x3f803f80,0x3f803f80
.long 0,0,0,0,0,0,0,0
.long 0,0,0,0,0,0,0,0
.long 0,0,0,0,0,0,0,0
.long 0,0,0,0,0,0,0,0
.long 0,0,0,0,0,0,0,0
.long 0,0,0,0,0,0,0,0
.long 0x3f80,0,0,0,0x3f803f80,0,0,0
.long 0x3f803f80,0x3f80,0,0,0x3f803f80,0x3f803f80,0,0
.long 0,0,0,0,0,0,0,0
.long 0,0,0,0,0,0,0,0
.long 0,0,0,0,0,0,0,0
.long 0,0,0,0,0,0,0,0
.long 0,0,0,0,0,0,0,0
.long 0,0,0,0,0,0,0,0
.long 0,0,0,0,0,0,0,0
.long 0,0,0,0,0,0,0,0
.long 0,0,0,0,0,0,0,0
.long 0,0,0,0,0,0,0,0
.long 0,0,0,0,0,0,0,0
.long 0,0,0,0,0,0,0,0
.long 0,0,0,0,0,0,0,0
.long 0,0,0,0,0,0,0,0
.long 0,0,0,0,0,0,0,0
.long 0,0,0,0,0,0,0,0
.long 0,0,0,0,0,0,0,0
.long 0,0,0,0,0,0,0,0
.long 0,0,0,0,0,0,0,0
.long 0,0,0,0,0,0,0,0
.long 0,0,0,0,0,0,0,0
.long 0,0,0,0,0,0,0,0
.long 0,0,0,0,0,0,0,0
.long 0,0,0,0,0,0,0,0
.long 0,0,0x3f800000,0x3f803f80,0,0,0,0x3f803f80
.long 0,0,0,0x3f800000,0,0,0,0
.long 0,0,0,0,0,0,0,0
.long 0,0,0,0,0,0,0,0
.long 0,0,0,0,0,0,0,0
.long 0,0,0,0,0,0,0,0
.long 0,0,0,0,0,0,0,0
.long 0,0,0,0,0,0,0,0
.long 0x3f803f80,0x3f803f80,0,0,0x3f803f80,0x3f803f80,0x3f80,0
.long 0x3f803f80,0x3f803f80,0x3f803f80,0,0x3f803f80,0x3f803f80,0x3f803f80,0x3f80
.long 0x3f800000,0x3f803f80,0x3f803f80,0x3f803f80,0,0x3f803f80,0x3f803f80,0x3f803f80
.long 0,0x3f800000,0x3f803f80,0x3f803f80,0,0,0x3f803f80,0x3f803f80
.long 0,0,0x3f800000,0x3f803f80,0,0,0,0x3f803f80
.long 0,0,0,0x3f800000,0,0,0,0
.long 0,0,0,0,0,0,0,0
.long 0,0,0,0,0,0,0,0
.long 0,0,0,0,0,0,0,0
.long 0,0,0,0,0,0,0,0
.long 0,0,0,0,0x3f80,0,0,0
.long 0x3f803f80,0,0,0,0x3f803f80,0x3f80,0,0
.long 0x3f803f80,0x3f803f80,0,0,0x3f803f80,0x3f803f80,0x3f80,0
.long 0x3f803f80,0x3f803f80,0x3f803f80,0,0x3f803f80,0x3f803f80,0x3f803f80,0x3f80
.long 0x3f800000,0x3f803f80,0x3f803f80,0x3f803f80,0,0x3f803f80,0x3f803f80,0x3f803f80
.long 0,0x3f800000,0x3f803f80,0x3f803f80,0,0,0x3f803f80,0x3f803f80
.long 0,0,0,0,0,0,0,0
.long 0,0,0,0,0,0,0,0
.long 0,0,0,0,0,0,0,0
.long 0,0,0,0,0,0,0,0
.long 0,0,0,0,0,0,0,0
.long 0,0,0,0,0,0,0,0
.long 0,0,0,0,0x3f80,0,0,0
.long 0x3f803f80,0,0,0,0x3f803f80,0x3f80,0,0
L_tbl_end:
.size L_tbl, 19456
.section .rodata,"a"
.p2align 6
.amdhsa_kernel concat_heads__ssm_conv_s4d__spectral_gfnet__prompt_kernel
  .amdhsa_next_free_vgpr 128
  .amdhsa_next_free_sgpr 102
  .amdhsa_accum_offset 128
  .amdhsa_group_segment_fixed_size 0
  .amdhsa_kernarg_size 104
  .amdhsa_user_sgpr_count 2
  .amdhsa_user_sgpr_kernarg_segment_ptr 1
  .amdhsa_system_sgpr_workgroup_id_x 1
.end_amdhsa_kernel
```
